```python
import torch

def _softmax(x, axis=-1):
    return torch.softmax(x, dim=axis)
def _gelu(x):
    return torch.nn.functional.gelu(x, approximate="tanh")
def _silu(x):
    return torch.nn.functional.silu(x)
def _sigmoid(x):
    return torch.sigmoid(x)
def _layernorm(x, axis=-1, eps=1e-5):
    m = x.mean(dim=axis, keepdim=True)
    v = x.var(dim=axis, keepdim=True, unbiased=False)
    return (x - m) / torch.sqrt(v + eps)
def _scatter_add(tgt, idx, src, axis=0):
    return tgt.clone().index_add_(axis, idx, src)
def _segment_sum(src, seg, n):
    out = torch.zeros((n,) + src.shape[1:], dtype=src.dtype)
    return out.index_add_(0, seg, src)
def _pad(x, pw):
    flat = tuple(v for pair in reversed(pw) for v in pair)
    return torch.nn.functional.pad(x, flat)

kernel_name = 'gated_mix__sliding_block__mixer_channel_mlp__prompt'

def setup_inputs():

    _w = (lambda a: (lambda t: t.to(torch.bfloat16) if t.is_floating_point() else t)(torch.as_tensor(a)))
    def _A_setup():
        B, S, D = 1, 2048, 512
        return {
            "x": _w((lambda *s: torch.randn(*s, dtype=torch.bfloat16) * 0.05)(B, S, D)),
            "wqkv": _w((lambda *s: torch.randn(*s, dtype=torch.bfloat16) * 0.8)(D, 3 * D)),
            "wo": _w((lambda *s: torch.randn(*s, dtype=torch.bfloat16) * 0.05)(D, D)),
        }
    _A_in = _A_setup()

    def _B_setup():
        B, S, D, F = 1, 2048, 512, 1376
        return {
            "x": _w((lambda *s: torch.randn(*s, dtype=torch.bfloat16) * 0.05)(B, S, D)),
            "w1": _w((lambda *s: torch.randn(*s, dtype=torch.bfloat16) * 3.2)(D, F) * (D ** -0.5)),
            "b1": _w((lambda *s: torch.randn(*s, dtype=torch.bfloat16) * 1.6)(F)),
            "w2": _w((lambda *s: torch.randn(*s, dtype=torch.bfloat16) * 0.2)(F, D) * (F ** -0.5)),
            "b2": _w((lambda *s: torch.randn(*s, dtype=torch.bfloat16) * 0.2)(D)),
        }
    _B_in = _B_setup()

    return {
        "A_x": _A_in["x"],
        "A_wqkv": _A_in["wqkv"],
        "A_wo": _A_in["wo"],
        "B_x": _B_in["x"],
        "B_w1": _B_in["w1"],
        "B_b1": _B_in["b1"],
        "B_w2": _B_in["w2"],
        "B_b2": _B_in["b2"],
        "gate_w": _w((lambda *s: torch.randn(*s, dtype=torch.bfloat16) * 0.05)(512) * 16.0),
    }

def reference(A_x, A_wqkv, A_wo, B_x, B_w1, B_b1, B_w2, B_b2, gate_w):
    def _A_ref(x, wqkv, wo):
        B, S, D = x.shape
        H = 32; Dh = D // H; W = 256
        qkv = (lambda x, *d: x.permute(*d))((x @ wqkv).reshape(B, S, 3, H, Dh), 2, 0, 3, 1, 4)
        q, k, v = qkv[0], qkv[1], qkv[2]
        scores = torch.einsum("bhqd,bhkd->bhqk", q, k) * (Dh ** -0.5)
        idx = torch.arange(S)
        mask = (idx[:, None] - idx[None, :] >= 0) & (idx[:, None] - idx[None, :] < W)
        scores = torch.where(mask[None, None], scores, -1e9)
        p = _softmax(scores, axis=-1)
        o = torch.einsum("bhqk,bhkd->bhqd", p, v)
        return (lambda x, *d: x.permute(*d))(o, 0, 2, 1, 3).reshape(B, S, D) @ wo

    def _B_ref(x, w1, b1, w2, b2):
        y = _layernorm(x, axis=-1)
        h = _gelu(torch.einsum("bsd,df->bsf", y, w1) + b1)
        return torch.einsum("bsf,fd->bsd", h, w2) + b2

    x = A_x
    g = _sigmoid((x * gate_w).sum(-1, keepdims=True))
    a = _A_ref(x, A_wqkv, A_wo)
    b = _B_ref(x, B_w1, B_b1, B_w2, B_b2)
    return g * a + (1 - g) * b
```

```asm
; @launch grid=(256,1,1) block=(512,1,1) lds=163840
.amdgcn_target "amdgcn-amd-amdhsa--gfx950"
.text
.globl gated_mix__sliding_block__mixer_channel_mlp__prompt_kernel
.p2align 8
.type gated_mix__sliding_block__mixer_channel_mlp__prompt_kernel,@function
gated_mix__sliding_block__mixer_channel_mlp__prompt_kernel:
    s_cmp_ge_u32 s2, 0x100
    s_cbranch_scc1 L_end
    s_load_dwordx2 s[40:41], s[0:1], 0
    s_load_dwordx2 s[44:45], s[0:1], 8
    s_load_dwordx2 s[32:33], s[0:1], 64
    s_getpc_b64 s[96:97]
L_pc0:
    s_bfe_u32 s8, s2, 0x30003
    v_and_b32 v28, 31, v0
    v_lshlrev_b32 v28, 3, v28
    v_add_lshl_u32 v28, v28, s8, 7
    v_min_u32 v28, CODE_LAST, v28
    v_cmp_gt_u32 vcc, 32, v0
    s_nop 0
    s_cbranch_vccz L_nocpf
    global_load_dword v29, v28, s[96:97]
L_nocpf:
    v_lshrrev_b32 v30, 6, v0
    v_and_b32 v0, 63, v0
    v_readfirstlane_b32 s4, v30
    s_and_b32 s3, s2, 6
    s_lshl_b32 s3, s3, 1
    s_lshr_b32 s7, s2, 6
    s_add_u32 s7, s7, s3
    s_and_b32 s3, s2, 1
    s_lshl_b32 s3, s3, 3
    s_add_u32 s8, s8, s3
    v_lshrrev_b32 v240, 3, v0
    v_and_b32 v241, 7, v0
    v_lshrrev_b32 v242, 4, v0
    s_lshl_b32 s9, s4, 10
    s_lshl_b32 s10, s4, 11
    s_lshl_b32 s3, s7, 3
    s_add_u32 s3, s3, s4
    s_lshl_b32 s3, s3, 14
    v_xor_b32 v251, v241, v242
    v_lshl_add_u32 v251, v251, 4, s3
    v_lshl_add_u32 v96, v240, 10, v251
    s_lshl_b32 s11, s7, 1
    s_add_u32 s11, s11, s8
    s_and_b32 s11, s11, 7
    s_lshl_b32 s11, s11, 7
    v_xor_b32 v97, 64, v96
    v_add_u32 v97, 7168, v97
    v_and_b32 v246, 1, v242
    v_lshlrev_b32 v243, 2, v246
    v_xor_b32 v243, v243, v241
    v_lshlrev_b32 v243, 4, v243
    s_mul_i32 s12, s4, 24576
    s_lshl_b32 s3, s8, 7
    s_add_u32 s12, s12, s3
    v_mul_u32_u24 v98, 3072, v240
    v_add3_u32 v98, v98, v243, s12
    s_mov_b32 s42, 2097152
    s_mov_b32 s43, 0x00020000
    s_mov_b32 s46, 1572864
    s_mov_b32 s47, 0x00020000
    s_mov_b32 s34, 1024
    s_mov_b32 s35, 0x00020000
    s_and_b32 s5, s4, 3
    s_lshl_b32 s14, s5, 8
    s_add_u32 s3, s14, s11
    v_lshl_add_u32 v252, v0, 2, s3
    v_and_b32 v252, 0x3ff, v252
    s_waitcnt lgkmcnt(0)
    s_add_u32 m0, s10, 0
    s_mul_i32 s12, s11, 1536
    buffer_load_dwordx4 v96, s[40:43], s11 offen lds
    buffer_load_dwordx4 v97, s[40:43], s11 offen offset:1024 lds
    s_add_u32 m0, s9, 64512
    s_add_u32 s11, s11, 128
    s_bitset0_b32 s11, 10
    buffer_load_dwordx4 v98, s[44:47], s12 offen offset:1024 lds
    s_add_u32 m0, s14, 155648
    s_nop 0
    buffer_load_dword v252, s[32:35], 0 offen lds
    s_load_dwordx2 s[48:49], s[0:1], 32
    s_load_dwordx2 s[56:57], s[0:1], 48
    s_load_dwordx2 s[60:61], s[0:1], 16
    s_load_dwordx2 s[64:65], s[0:1], 88
    s_load_dwordx2 s[36:37], s[0:1], 40
    s_load_dwordx2 s[76:77], s[0:1], 56
    s_load_dwordx2 s[68:69], s[0:1], 72
    s_barrier
    s_mov_b32 s50, 1409024
    s_mov_b32 s51, 0x00020000
    s_mov_b32 s58, 1409024
    s_mov_b32 s59, 0x00020000
    s_mov_b32 s62, 524288
    s_mov_b32 s63, 0x00020000
    s_mov_b32 s66, 13369344
    s_mov_b32 s67, 0x00020000
    s_add_u32 m0, s10, 16384
    s_mul_i32 s12, s11, 1536
    buffer_load_dwordx4 v96, s[40:43], s11 offen lds
    buffer_load_dwordx4 v97, s[40:43], s11 offen offset:1024 lds
    s_add_u32 m0, s9, 72704
    s_add_u32 s11, s11, 128
    s_bitset0_b32 s11, 10
    buffer_load_dwordx4 v98, s[44:47], s12 offen offset:1024 lds
    s_waitcnt lgkmcnt(0)
    s_getpc_b64 s[96:97]
    s_add_u32 s96, s96, L_tab@rel32@lo+4
    s_addc_u32 s97, s97, L_tab@rel32@hi+12
    s_lshl_b32 s3, s2, 3
    s_add_u32 s3, s3, s4
    s_lshl_b32 s3, s3, 7
    s_add_u32 s14, s3, 64
    s_load_dwordx16 s[16:31], s[96:97], s3
    s_load_dwordx16 s[80:95], s[96:97], s14
    s_barrier
    buffer_load_dword v99, off, s[64:67], 0 sc1
    s_cmp_lg_u32 s4, 0
    s_cbranch_scc1 L_pf_2
    s_mov_b32 s38, 2752
    s_mov_b32 s39, 0x00020000
    s_mov_b32 s3, 0
    v_lshlrev_b32 v58, 7, v0
    buffer_load_dword v31, v58, s[36:39], s3 offen offset:0
    s_branch L_pfe_1
L_pf_2:
    s_cmp_lg_u32 s4, 1
    s_cbranch_scc1 L_pf_3
    s_mov_b32 s78, 1024
    s_mov_b32 s79, 0x00020000
    s_mov_b32 s3, 0
    v_lshlrev_b32 v58, 7, v0
    buffer_load_dword v31, v58, s[76:79], s3 offen offset:0
    s_branch L_pfe_1
L_pf_3:
    s_cmp_lg_u32 s4, 2
    s_cbranch_scc1 L_pf_4
    s_lshl_b32 s3, s2, 9
    s_add_u32 s3, s3, 65536
    v_and_b32 v58, 3, v0
    v_lshlrev_b32 v58, 7, v58
    buffer_load_dword v31, v58, s[64:67], s3 offen offset:0 sc1
    s_branch L_pfe_1
L_pf_4:
    buffer_load_dword v31, off, s[32:35], 0
L_pfe_1:
    s_nop 0
    s_lshr_b32 s6, s4, 2
    s_lshl_b32 s13, s6, 1
    s_xor_b32 s13, s13, s5
    v_lshrrev_b32 v245, 5, v0
    v_bfe_u32 v247, v0, 2, 2
    v_and_b32 v248, 3, v0
    v_lshlrev_b32 v248, 3, v248
    v_and_b32 v249, 31, v0
    v_lshl_add_u32 v250, v245, 3, v247
    s_lshl_b32 s3, s5, 5
    v_add_lshl_u32 v251, v249, s3, 7
    v_bfe_u32 v252, v249, 1, 3
    s_lshl_b32 s3, s13, 1
    v_xor_b32 v252, v252, v245
    v_xor_b32 v252, s3, v252
    v_lshl_add_u32 v100, v252, 4, v251
    v_xor_b32 v101, 32, v100
    v_xor_b32 v102, 64, v100
    v_xor_b32 v103, 96, v100
    v_lshrrev_b32 v252, 1, v247
    v_xor_b32 v252, s6, v252
    v_lshl_add_u32 v253, v246, 5, v248
    v_lshl_add_u32 v252, v252, 6, v253
    s_lshl_b32 s3, s13, 11
    s_add_u32 s3, s3, 65536
    v_lshl_add_u32 v252, v250, 7, v252
    v_add_u32 v104, s3, v252
    v_xor_b32 v105, 2048, v104
    v_xor_b32 v106, 4096, v104
    v_xor_b32 v107, 6144, v104
    s_lshl_b32 s3, s13, 5
    s_add_u32 s3, s3, 155648
    v_lshl_add_u32 v108, v245, 4, s3
    v_xor_b32 v109, 32, v108
    s_mov_b32 s74, 0x3f803f80
    v_lshlrev_b32 v1, 4, v0
    v_mov_b64 v[10:11], 0
    v_mov_b64 v[12:13], 0
    v_mov_b64 v[14:15], 0
    s_mov_b32 s70, 2097152
    s_mov_b32 s71, 0x00020000
    s_mov_b32 s38, 2752
    s_mov_b32 s39, 0x00020000
    s_mov_b32 s78, 1024
    s_mov_b32 s79, 0x00020000
    s_bitcmp1_b32 s4, 0
    s_cselect_b64 s[52:53], s[44:45], s[48:49]
    s_cselect_b32 s54, s46, s50
    s_mov_b32 s55, 0x00020000
    s_mov_b32 s73, 0x40000
    s_mul_i32 s75, s4, 6144
    v_mov_b32 v76, s74
    v_mov_b32 v77, s74
    v_mov_b32 v78, s74
    v_mov_b32 v79, s74
    v_mov_b32 v80, s74
    v_mov_b32 v81, s74
    v_mov_b32 v82, s74
    v_mov_b32 v83, s74
    v_mov_b32 v84, s74
    v_mov_b32 v85, s74
    v_mov_b32 v86, s74
    v_mov_b32 v87, s74
    v_mov_b32 v88, s74
    v_mov_b32 v89, s74
    v_mov_b32 v90, s74
    v_mov_b32 v91, s74
    s_mov_b32 vcc_lo, 0xaaaa5555
    s_mov_b32 vcc_hi, 0xaaaa5555
    v_cndmask_b32 v72, 0, v76, vcc
    v_cndmask_b32 v73, 0, v76, vcc
    v_cndmask_b32 v74, 0, v76, vcc
    v_cndmask_b32 v75, 0, v76, vcc
    s_and_b32 s3, s4, 1
    s_cselect_b64 vcc, -1, 0
    s_lshl_b32 s3, s3, 7
    v_add_u32 v251, s3, v0
    v_mul_u32_u24 v252, 171, v251
    v_lshrrev_b32 v252, 11, v252
    v_mul_u32_u24 v253, 2560, v252
    v_lshl_add_u32 v3, v251, 4, v253
    v_add_u32 v251, 64, v0
    v_mul_u32_u24 v252, 171, v251
    v_lshrrev_b32 v252, 11, v252
    v_mul_u32_u24 v253, 2560, v252
    v_lshl_add_u32 v4, v251, 4, v253
    v_lshrrev_b32 v251, 2, v0
    v_mul_u32_u24 v251, 3072, v251
    v_lshl_add_u32 v251, v248, 1, v251
    v_cndmask_b32 v4, v4, v251, vcc
    v_lshl_add_u32 v2, v240, 10, v243
    v_mul_u32_u24 v17, 192, v250
    v_add_u32 v17, v17, v248
    v_lshl_add_u32 v24, v246, 5, v17
    v_lshl_add_u32 v16, v250, 6, v248
    v_lshlrev_b32 v20, 9, v246
    v_add_u32 v20, 256, v20
    v_lshlrev_b32 v252, 1, v249
    v_lshl_add_u32 v252, v245, 25, v252
    v_xor_b32 v251, 1, v246
    v_lshl_add_u32 v251, v251, 26, v252
    v_and_b32 v9, 0x2f0, v1
    v_bfe_u32 v92, v0, 2, 3
    v_lshl_add_u32 v92, v92, 7, v248
    v_lshl_add_u32 v94, v245, 2, v247
    v_lshl_add_u32 v94, v94, 7, v248
    v_lshrrev_b32 v253, 1, v247
    v_lshl_add_u32 v94, v253, 6, v94
    v_lshl_add_u32 v94, v246, 5, v94
    v_min_u32 v93, 2, v247
    v_sub_u32 v93, s7, v93
    v_max_i32 v93, 0, v93
    v_lshl_add_u32 v93, v246, 8, v93
    v_lshl_add_u32 v93, v93, 7, v248
    s_mov_b32 vcc_lo, 0xffff0000
    s_mov_b32 vcc_hi, 0xffff0000
    s_waitcnt vmcnt(5)
    s_barrier
    s_cmp_eq_u32 s6, 0
    s_cbranch_scc1 L_nostag
    s_barrier
L_nostag:
    s_cmp_ge_u32 s8, 8
    s_cbranch_scc1 L_p1v
    ds_read_b128 v[128:131], v100 offset:0
    ds_read_b64_tr_b16 v[32:33], v104 offset:0
    ds_read_b64_tr_b16 v[34:35], v104 offset:512
    ds_read_b128 v[132:135], v101 offset:0
    ds_read_b64_tr_b16 v[36:37], v105 offset:0
    ds_read_b64_tr_b16 v[38:39], v105 offset:512
    ds_read_b128 v[136:139], v102 offset:0
    ds_read_b64_tr_b16 v[40:41], v106 offset:0
    ds_read_b64_tr_b16 v[42:43], v106 offset:512
    ds_read_b128 v[140:143], v103 offset:0
    ds_read_b64_tr_b16 v[44:45], v107 offset:0
    ds_read_b64_tr_b16 v[46:47], v107 offset:512
    ds_read_b128 v[48:51], v108 offset:0
    ds_read_b128 v[52:55], v109 offset:0
    s_add_u32 m0, s10, 32768
    s_mul_i32 s12, s11, 1536
    buffer_load_dwordx4 v96, s[40:43], s11 offen lds
    buffer_load_dwordx4 v97, s[40:43], s11 offen offset:1024 lds
    s_add_u32 m0, s9, 80896
    s_add_u32 s11, s11, 128
    s_bitset0_b32 s11, 10
    buffer_load_dwordx4 v98, s[44:47], s12 offen offset:1024 lds
    s_add_u32 m0, s10, 49152
    s_mul_i32 s12, s11, 1536
    buffer_load_dwordx4 v96, s[40:43], s11 offen lds
    buffer_load_dwordx4 v97, s[40:43], s11 offen offset:1024 lds
    s_add_u32 m0, s9, 89088
    s_add_u32 s11, s11, 128
    s_bitset0_b32 s11, 10
    buffer_load_dwordx4 v98, s[44:47], s12 offen offset:1024 lds
    s_waitcnt lgkmcnt(0)
    s_waitcnt vmcnt(8)
    s_barrier
    v_mfma_f32_32x32x16_bf16 v[112:127], v[32:35], v[128:131], 0
    v_add_u32 v251, s22, v251
    v_add_u32 v3, s16, v3
    v_mfma_f32_32x32x16_bf16 v[112:127], v[36:39], v[132:135], v[112:127]
    v_add_u32 v4, s17, v4
    s_mov_b32 s15, s31
    v_mfma_f32_32x32x16_bf16 v[112:127], v[40:43], v[136:139], v[112:127]
    v_add_u32 v2, s18, v2
    buffer_load_ushort v60, v251, s[36:39], 0 offen
    v_mfma_f32_32x32x16_bf16 v[112:127], v[44:47], v[140:143], v[112:127]
    buffer_load_ushort v61, v252, s[36:39], s23 offen
    buffer_load_ushort v62, v252, s[76:79], s24 offen
    v_dot2c_f32_bf16 v10, s74, v128
    v_dot2c_f32_bf16 v12, v128, v128
    v_dot2c_f32_bf16 v14, v48, v128
    v_dot2c_f32_bf16 v11, s74, v129
    v_dot2c_f32_bf16 v13, v129, v129
    v_dot2c_f32_bf16 v15, v49, v129
    v_dot2c_f32_bf16 v10, s74, v130
    v_dot2c_f32_bf16 v12, v130, v130
    v_dot2c_f32_bf16 v14, v50, v130
    v_dot2c_f32_bf16 v11, s74, v131
    v_dot2c_f32_bf16 v13, v131, v131
    v_dot2c_f32_bf16 v15, v51, v131
    v_dot2c_f32_bf16 v10, s74, v132
    v_dot2c_f32_bf16 v12, v132, v132
    v_dot2c_f32_bf16 v14, v52, v132
    v_dot2c_f32_bf16 v11, s74, v133
    v_dot2c_f32_bf16 v13, v133, v133
    v_dot2c_f32_bf16 v15, v53, v133
    v_dot2c_f32_bf16 v10, s74, v134
    v_dot2c_f32_bf16 v12, v134, v134
    v_dot2c_f32_bf16 v14, v54, v134
    v_dot2c_f32_bf16 v11, s74, v135
    v_dot2c_f32_bf16 v13, v135, v135
    v_dot2c_f32_bf16 v15, v55, v135
    s_barrier
    ds_read_b128 v[144:147], v100 offset:16384
    ds_read_b64_tr_b16 v[32:33], v104 offset:8192
    ds_read_b64_tr_b16 v[34:35], v104 offset:8704
    ds_read_b128 v[148:151], v101 offset:16384
    ds_read_b64_tr_b16 v[36:37], v105 offset:8192
    ds_read_b64_tr_b16 v[38:39], v105 offset:8704
    ds_read_b128 v[152:155], v102 offset:16384
    ds_read_b64_tr_b16 v[40:41], v106 offset:8192
    ds_read_b64_tr_b16 v[42:43], v106 offset:8704
    ds_read_b128 v[156:159], v103 offset:16384
    ds_read_b64_tr_b16 v[44:45], v107 offset:8192
    ds_read_b64_tr_b16 v[46:47], v107 offset:8704
    ds_read_b128 v[48:51], v108 offset:128
    ds_read_b128 v[52:55], v109 offset:128
    s_cmp_lg_u32 s4, 0
    s_cbranch_scc1 L_pf_7
    s_mul_i32 s3, s2, 5504
    v_min_u32 v58, 42, v0
    v_lshlrev_b32 v58, 7, v58
    buffer_load_dword v31, v58, s[48:51], s3 offen offset:0
    s_branch L_pfe_6
L_pf_7:
    s_cmp_lg_u32 s4, 1
    s_cbranch_scc1 L_pf_8
    s_mul_i32 s3, s2, 6144
    v_min_u32 v58, 1, v240
    v_mul_u32_u24 v58, 24, v58
    v_add_lshl_u32 v58, v58, v241, 7
    buffer_load_dword v31, v58, s[44:47], s3 offen offset:0
    s_branch L_pfe_6
L_pf_8:
    buffer_load_dword v31, off, s[32:35], 0
L_pfe_6:
    s_nop 0
    s_add_u32 m0, s10, 0
    s_mul_i32 s12, s11, 1536
    buffer_load_dwordx4 v96, s[40:43], s11 offen lds
    buffer_load_dwordx4 v97, s[40:43], s11 offen offset:1024 lds
    s_add_u32 m0, s9, 64512
    s_add_u32 s11, s11, 128
    s_bitset0_b32 s11, 10
    buffer_load_dwordx4 v98, s[44:47], s12 offen offset:1024 lds
    s_waitcnt lgkmcnt(0)
    s_waitcnt vmcnt(10)
    s_barrier
    v_mfma_f32_32x32x16_bf16 v[112:127], v[32:35], v[144:147], v[112:127]
    buffer_load_ushort v63, v252, s[76:79], s24 offen offset:64
    v_add_u32 v24, s19, v24
    v_mfma_f32_32x32x16_bf16 v[112:127], v[36:39], v[148:151], v[112:127]
    v_add_u32 v16, s20, v16
    v_add_u32 v17, s21, v17
    v_mfma_f32_32x32x16_bf16 v[112:127], v[40:43], v[152:155], v[112:127]
    v_cndmask_b32 v16, v16, v17, vcc
    v_add_u32 v20, v16, v20
    v_mfma_f32_32x32x16_bf16 v[112:127], v[44:47], v[156:159], v[112:127]
    v_xor_b32 v17, 4096, v16
    v_xor_b32 v18, 8192, v16
    v_dot2c_f32_bf16 v10, s74, v144
    v_dot2c_f32_bf16 v12, v144, v144
    v_dot2c_f32_bf16 v14, v48, v144
    v_dot2c_f32_bf16 v11, s74, v145
    v_dot2c_f32_bf16 v13, v145, v145
    v_dot2c_f32_bf16 v15, v49, v145
    v_dot2c_f32_bf16 v10, s74, v146
    v_dot2c_f32_bf16 v12, v146, v146
    v_dot2c_f32_bf16 v14, v50, v146
    v_dot2c_f32_bf16 v11, s74, v147
    v_dot2c_f32_bf16 v13, v147, v147
    v_dot2c_f32_bf16 v15, v51, v147
    v_dot2c_f32_bf16 v10, s74, v148
    v_dot2c_f32_bf16 v12, v148, v148
    v_dot2c_f32_bf16 v14, v52, v148
    v_dot2c_f32_bf16 v11, s74, v149
    v_dot2c_f32_bf16 v13, v149, v149
    v_dot2c_f32_bf16 v15, v53, v149
    v_dot2c_f32_bf16 v10, s74, v150
    v_dot2c_f32_bf16 v12, v150, v150
    v_dot2c_f32_bf16 v14, v54, v150
    v_dot2c_f32_bf16 v11, s74, v151
    v_dot2c_f32_bf16 v13, v151, v151
    v_dot2c_f32_bf16 v15, v55, v151
    s_barrier
    ds_read_b128 v[160:163], v100 offset:32768
    ds_read_b64_tr_b16 v[32:33], v104 offset:16384
    ds_read_b64_tr_b16 v[34:35], v104 offset:16896
    ds_read_b128 v[164:167], v101 offset:32768
    ds_read_b64_tr_b16 v[36:37], v105 offset:16384
    ds_read_b64_tr_b16 v[38:39], v105 offset:16896
    ds_read_b128 v[168:171], v102 offset:32768
    ds_read_b64_tr_b16 v[40:41], v106 offset:16384
    ds_read_b64_tr_b16 v[42:43], v106 offset:16896
    ds_read_b128 v[172:175], v103 offset:32768
    ds_read_b64_tr_b16 v[44:45], v107 offset:16384
    ds_read_b64_tr_b16 v[46:47], v107 offset:16896
    ds_read_b128 v[48:51], v108 offset:256
    ds_read_b128 v[52:55], v109 offset:256
    s_add_u32 m0, s10, 16384
    s_mul_i32 s12, s11, 1536
    buffer_load_dwordx4 v96, s[40:43], s11 offen lds
    buffer_load_dwordx4 v97, s[40:43], s11 offen offset:1024 lds
    s_add_u32 m0, s9, 72704
    s_add_u32 s11, s11, 128
    s_bitset0_b32 s11, 10
    buffer_load_dwordx4 v98, s[44:47], s12 offen offset:1024 lds
    v_readfirstlane_b32 s100, v99
    s_nop 0
    s_add_u32 s100, s100, 1
    s_xor_b32 s101, s100, 0x5bd1e995
    s_waitcnt lgkmcnt(0)
    s_waitcnt vmcnt(11)
    s_barrier
    v_mfma_f32_32x32x16_bf16 v[112:127], v[32:35], v[160:163], v[112:127]
    v_xor_b32 v19, 12288, v16
    v_xor_b32 v21, 4096, v20
    v_mfma_f32_32x32x16_bf16 v[112:127], v[36:39], v[164:167], v[112:127]
    v_xor_b32 v22, 8192, v20
    v_xor_b32 v23, 12288, v20
    v_mfma_f32_32x32x16_bf16 v[112:127], v[40:43], v[168:171], v[112:127]
    v_xor_b32 v25, 4096, v24
    v_xor_b32 v26, 8192, v24
    v_mfma_f32_32x32x16_bf16 v[112:127], v[44:47], v[172:175], v[112:127]
    v_xor_b32 v27, 12288, v24
    v_add_u32 v8, s25, v1
    v_dot2c_f32_bf16 v10, s74, v160
    v_dot2c_f32_bf16 v12, v160, v160
    v_dot2c_f32_bf16 v14, v48, v160
    v_dot2c_f32_bf16 v11, s74, v161
    v_dot2c_f32_bf16 v13, v161, v161
    v_dot2c_f32_bf16 v15, v49, v161
    v_dot2c_f32_bf16 v10, s74, v162
    v_dot2c_f32_bf16 v12, v162, v162
    v_dot2c_f32_bf16 v14, v50, v162
    v_dot2c_f32_bf16 v11, s74, v163
    v_dot2c_f32_bf16 v13, v163, v163
    v_dot2c_f32_bf16 v15, v51, v163
    v_dot2c_f32_bf16 v10, s74, v164
    v_dot2c_f32_bf16 v12, v164, v164
    v_dot2c_f32_bf16 v14, v52, v164
    v_dot2c_f32_bf16 v11, s74, v165
    v_dot2c_f32_bf16 v13, v165, v165
    v_dot2c_f32_bf16 v15, v53, v165
    v_dot2c_f32_bf16 v10, s74, v166
    v_dot2c_f32_bf16 v12, v166, v166
    v_dot2c_f32_bf16 v14, v54, v166
    v_dot2c_f32_bf16 v11, s74, v167
    v_dot2c_f32_bf16 v13, v167, v167
    v_dot2c_f32_bf16 v15, v55, v167
    s_barrier
    ds_read_b128 v[176:179], v100 offset:49152
    ds_read_b64_tr_b16 v[32:33], v104 offset:24576
    ds_read_b64_tr_b16 v[34:35], v104 offset:25088
    ds_read_b128 v[180:183], v101 offset:49152
    ds_read_b64_tr_b16 v[36:37], v105 offset:24576
    ds_read_b64_tr_b16 v[38:39], v105 offset:25088
    ds_read_b128 v[184:187], v102 offset:49152
    ds_read_b64_tr_b16 v[40:41], v106 offset:24576
    ds_read_b64_tr_b16 v[42:43], v106 offset:25088
    ds_read_b128 v[188:191], v103 offset:49152
    ds_read_b64_tr_b16 v[44:45], v107 offset:24576
    ds_read_b64_tr_b16 v[46:47], v107 offset:25088
    ds_read_b128 v[48:51], v108 offset:384
    ds_read_b128 v[52:55], v109 offset:384
    s_add_u32 m0, s10, 32768
    s_mul_i32 s12, s11, 1536
    buffer_load_dwordx4 v96, s[40:43], s11 offen lds
    buffer_load_dwordx4 v97, s[40:43], s11 offen offset:1024 lds
    s_add_u32 m0, s9, 80896
    s_add_u32 s11, s11, 128
    s_bitset0_b32 s11, 10
    buffer_load_dwordx4 v98, s[44:47], s12 offen offset:1024 lds
    s_waitcnt lgkmcnt(0)
    s_waitcnt vmcnt(7)
    s_barrier
    v_mfma_f32_32x32x16_bf16 v[112:127], v[32:35], v[176:179], v[112:127]
    v_add_u32 v9, s26, v9
    v_add_u32 v92, s27, v92
    v_mfma_f32_32x32x16_bf16 v[112:127], v[36:39], v[180:183], v[112:127]
    v_add_u32 v93, s29, v93
    v_add_u32 v94, s28, v94
    v_mfma_f32_32x32x16_bf16 v[112:127], v[40:43], v[184:187], v[112:127]
    v_xor_b32 v95, 64, v94
    s_mov_b32 s96, 0x0000ffff
    v_mfma_f32_32x32x16_bf16 v[112:127], v[44:47], v[188:191], v[112:127]
    s_mov_b32 s97, 0x0000ffff
    v_dot2c_f32_bf16 v10, s74, v176
    v_dot2c_f32_bf16 v12, v176, v176
    v_dot2c_f32_bf16 v14, v48, v176
    v_dot2c_f32_bf16 v11, s74, v177
    v_dot2c_f32_bf16 v13, v177, v177
    v_dot2c_f32_bf16 v15, v49, v177
    v_dot2c_f32_bf16 v10, s74, v178
    v_dot2c_f32_bf16 v12, v178, v178
    v_dot2c_f32_bf16 v14, v50, v178
    v_dot2c_f32_bf16 v11, s74, v179
    v_dot2c_f32_bf16 v13, v179, v179
    v_dot2c_f32_bf16 v15, v51, v179
    v_dot2c_f32_bf16 v10, s74, v180
    v_dot2c_f32_bf16 v12, v180, v180
    v_dot2c_f32_bf16 v14, v52, v180
    v_dot2c_f32_bf16 v11, s74, v181
    v_dot2c_f32_bf16 v13, v181, v181
    v_dot2c_f32_bf16 v15, v53, v181
    v_dot2c_f32_bf16 v10, s74, v182
    v_dot2c_f32_bf16 v12, v182, v182
    v_dot2c_f32_bf16 v14, v54, v182
    v_dot2c_f32_bf16 v11, s74, v183
    v_dot2c_f32_bf16 v13, v183, v183
    v_dot2c_f32_bf16 v15, v55, v183
    s_barrier
    ds_read_b128 v[192:195], v100 offset:0
    ds_read_b64_tr_b16 v[32:33], v104 offset:0
    ds_read_b64_tr_b16 v[34:35], v104 offset:512
    ds_read_b128 v[196:199], v101 offset:0
    ds_read_b64_tr_b16 v[36:37], v105 offset:0
    ds_read_b64_tr_b16 v[38:39], v105 offset:512
    ds_read_b128 v[200:203], v102 offset:0
    ds_read_b64_tr_b16 v[40:41], v106 offset:0
    ds_read_b64_tr_b16 v[42:43], v106 offset:512
    ds_read_b128 v[204:207], v103 offset:0
    ds_read_b64_tr_b16 v[44:45], v107 offset:0
    ds_read_b64_tr_b16 v[46:47], v107 offset:512
    ds_read_b128 v[48:51], v108 offset:512
    ds_read_b128 v[52:55], v109 offset:512
    s_add_u32 m0, s10, 49152
    s_mul_i32 s12, s11, 1536
    buffer_load_dwordx4 v96, s[40:43], s11 offen lds
    buffer_load_dwordx4 v97, s[40:43], s11 offen offset:1024 lds
    s_add_u32 m0, s9, 89088
    s_add_u32 s11, s11, 128
    s_bitset0_b32 s11, 10
    buffer_load_dwordx4 v98, s[44:47], s12 offen offset:1024 lds
    s_waitcnt lgkmcnt(0)
    s_waitcnt vmcnt(6)
    s_barrier
    v_mfma_f32_32x32x16_bf16 v[112:127], v[32:35], v[192:195], v[112:127]
    v_mfma_f32_32x32x16_bf16 v[112:127], v[36:39], v[196:199], v[112:127]
    v_mfma_f32_32x32x16_bf16 v[112:127], v[40:43], v[200:203], v[112:127]
    v_mfma_f32_32x32x16_bf16 v[112:127], v[44:47], v[204:207], v[112:127]
    v_dot2c_f32_bf16 v10, s74, v192
    v_dot2c_f32_bf16 v12, v192, v192
    v_dot2c_f32_bf16 v14, v48, v192
    v_dot2c_f32_bf16 v11, s74, v193
    v_dot2c_f32_bf16 v13, v193, v193
    v_dot2c_f32_bf16 v15, v49, v193
    v_dot2c_f32_bf16 v10, s74, v194
    v_dot2c_f32_bf16 v12, v194, v194
    v_dot2c_f32_bf16 v14, v50, v194
    v_dot2c_f32_bf16 v11, s74, v195
    v_dot2c_f32_bf16 v13, v195, v195
    v_dot2c_f32_bf16 v15, v51, v195
    v_dot2c_f32_bf16 v10, s74, v196
    v_dot2c_f32_bf16 v12, v196, v196
    v_dot2c_f32_bf16 v14, v52, v196
    v_dot2c_f32_bf16 v11, s74, v197
    v_dot2c_f32_bf16 v13, v197, v197
    v_dot2c_f32_bf16 v15, v53, v197
    v_dot2c_f32_bf16 v10, s74, v198
    v_dot2c_f32_bf16 v12, v198, v198
    v_dot2c_f32_bf16 v14, v54, v198
    v_dot2c_f32_bf16 v11, s74, v199
    v_dot2c_f32_bf16 v13, v199, v199
    v_dot2c_f32_bf16 v15, v55, v199
    s_barrier
    ds_read_b128 v[208:211], v100 offset:16384
    ds_read_b64_tr_b16 v[32:33], v104 offset:8192
    ds_read_b64_tr_b16 v[34:35], v104 offset:8704
    ds_read_b128 v[212:215], v101 offset:16384
    ds_read_b64_tr_b16 v[36:37], v105 offset:8192
    ds_read_b64_tr_b16 v[38:39], v105 offset:8704
    ds_read_b128 v[216:219], v102 offset:16384
    ds_read_b64_tr_b16 v[40:41], v106 offset:8192
    ds_read_b64_tr_b16 v[42:43], v106 offset:8704
    ds_read_b128 v[220:223], v103 offset:16384
    ds_read_b64_tr_b16 v[44:45], v107 offset:8192
    ds_read_b64_tr_b16 v[46:47], v107 offset:8704
    ds_read_b128 v[48:51], v108 offset:640
    ds_read_b128 v[52:55], v109 offset:640
    s_add_u32 m0, s10, 0
    s_mul_i32 s13, s11, 1376
    s_mul_i32 s14, s11, s15
    buffer_load_dwordx4 v3, s[48:51], s13 offen lds
    s_add_u32 m0, s10, 1024
    s_add_u32 s11, s11, 128
    s_bitset0_b32 s11, 10
    buffer_load_dwordx4 v4, s[52:55], s14 offen lds
    s_waitcnt lgkmcnt(0)
    s_waitcnt vmcnt(5)
    s_barrier
    v_mfma_f32_32x32x16_bf16 v[112:127], v[32:35], v[208:211], v[112:127]
    v_mfma_f32_32x32x16_bf16 v[112:127], v[36:39], v[212:215], v[112:127]
    v_mfma_f32_32x32x16_bf16 v[112:127], v[40:43], v[216:219], v[112:127]
    v_mfma_f32_32x32x16_bf16 v[112:127], v[44:47], v[220:223], v[112:127]
    s_getpc_b64 s[0:1]
L_pc_9:
    s_add_u32 s0, s0, L_masks-L_pc_9
    s_addc_u32 s1, s1, 0
    s_load_dwordx16 s[16:31], s[0:1], 0
    s_load_dwordx16 s[32:47], s[0:1], 64
    v_dot2c_f32_bf16 v10, s74, v208
    v_dot2c_f32_bf16 v12, v208, v208
    v_dot2c_f32_bf16 v14, v48, v208
    v_dot2c_f32_bf16 v11, s74, v209
    v_dot2c_f32_bf16 v13, v209, v209
    v_dot2c_f32_bf16 v15, v49, v209
    v_dot2c_f32_bf16 v10, s74, v210
    v_dot2c_f32_bf16 v12, v210, v210
    v_dot2c_f32_bf16 v14, v50, v210
    v_dot2c_f32_bf16 v11, s74, v211
    v_dot2c_f32_bf16 v13, v211, v211
    v_dot2c_f32_bf16 v15, v51, v211
    v_dot2c_f32_bf16 v10, s74, v212
    v_dot2c_f32_bf16 v12, v212, v212
    v_dot2c_f32_bf16 v14, v52, v212
    v_dot2c_f32_bf16 v11, s74, v213
    v_dot2c_f32_bf16 v13, v213, v213
    v_dot2c_f32_bf16 v15, v53, v213
    v_dot2c_f32_bf16 v10, s74, v214
    v_dot2c_f32_bf16 v12, v214, v214
    v_dot2c_f32_bf16 v14, v54, v214
    v_dot2c_f32_bf16 v11, s74, v215
    v_dot2c_f32_bf16 v13, v215, v215
    v_dot2c_f32_bf16 v15, v55, v215
    s_barrier
    ds_read_b128 v[224:227], v100 offset:32768
    ds_read_b64_tr_b16 v[32:33], v104 offset:16384
    ds_read_b64_tr_b16 v[34:35], v104 offset:16896
    ds_read_b128 v[228:231], v101 offset:32768
    ds_read_b64_tr_b16 v[36:37], v105 offset:16384
    ds_read_b64_tr_b16 v[38:39], v105 offset:16896
    ds_read_b128 v[232:235], v102 offset:32768
    ds_read_b64_tr_b16 v[40:41], v106 offset:16384
    ds_read_b64_tr_b16 v[42:43], v106 offset:16896
    ds_read_b128 v[236:239], v103 offset:32768
    ds_read_b64_tr_b16 v[44:45], v107 offset:16384
    ds_read_b64_tr_b16 v[46:47], v107 offset:16896
    ds_read_b128 v[48:51], v108 offset:768
    ds_read_b128 v[52:55], v109 offset:768
    s_add_u32 m0, s10, 16384
    s_mul_i32 s13, s11, 1376
    s_mul_i32 s14, s11, s15
    buffer_load_dwordx4 v3, s[48:51], s13 offen lds
    s_add_u32 m0, s10, 17408
    s_add_u32 s11, s11, 128
    s_bitset0_b32 s11, 10
    buffer_load_dwordx4 v4, s[52:55], s14 offen lds
    s_waitcnt lgkmcnt(0)
    s_waitcnt vmcnt(4)
    s_barrier
    v_mfma_f32_32x32x16_bf16 v[112:127], v[32:35], v[224:227], v[112:127]
    s_waitcnt vmcnt(13)
    v_mfma_f32_32x32x16_bf16 v[112:127], v[36:39], v[228:231], v[112:127]
    v_lshl_or_b32 v5, v61, 16, v60
    v_mfma_f32_32x32x16_bf16 v[112:127], v[40:43], v[232:235], v[112:127]
    v_lshl_or_b32 v6, v63, 16, v62
    v_mfma_f32_32x32x16_bf16 v[112:127], v[44:47], v[236:239], v[112:127]
    v_dot2c_f32_bf16 v10, s74, v224
    v_dot2c_f32_bf16 v12, v224, v224
    v_dot2c_f32_bf16 v14, v48, v224
    v_dot2c_f32_bf16 v11, s74, v225
    v_dot2c_f32_bf16 v13, v225, v225
    v_dot2c_f32_bf16 v15, v49, v225
    v_dot2c_f32_bf16 v10, s74, v226
    v_dot2c_f32_bf16 v12, v226, v226
    v_dot2c_f32_bf16 v14, v50, v226
    v_dot2c_f32_bf16 v11, s74, v227
    v_dot2c_f32_bf16 v13, v227, v227
    v_dot2c_f32_bf16 v15, v51, v227
    v_dot2c_f32_bf16 v10, s74, v228
    v_dot2c_f32_bf16 v12, v228, v228
    v_dot2c_f32_bf16 v14, v52, v228
    v_dot2c_f32_bf16 v11, s74, v229
    v_dot2c_f32_bf16 v13, v229, v229
    v_dot2c_f32_bf16 v15, v53, v229
    v_dot2c_f32_bf16 v10, s74, v230
    v_dot2c_f32_bf16 v12, v230, v230
    v_dot2c_f32_bf16 v14, v54, v230
    v_dot2c_f32_bf16 v11, s74, v231
    v_dot2c_f32_bf16 v13, v231, v231
    v_dot2c_f32_bf16 v15, v55, v231
    s_barrier
    ds_read_b128 v[240:243], v100 offset:49152
    ds_read_b64_tr_b16 v[32:33], v104 offset:24576
    ds_read_b64_tr_b16 v[34:35], v104 offset:25088
    ds_read_b128 v[244:247], v101 offset:49152
    ds_read_b64_tr_b16 v[36:37], v105 offset:24576
    ds_read_b64_tr_b16 v[38:39], v105 offset:25088
    ds_read_b128 v[248:251], v102 offset:49152
    ds_read_b64_tr_b16 v[40:41], v106 offset:24576
    ds_read_b64_tr_b16 v[42:43], v106 offset:25088
    ds_read_b128 v[252:255], v103 offset:49152
    ds_read_b64_tr_b16 v[44:45], v107 offset:24576
    ds_read_b64_tr_b16 v[46:47], v107 offset:25088
    ds_read_b128 v[48:51], v108 offset:896
    ds_read_b128 v[52:55], v109 offset:896
    s_add_u32 m0, s10, 32768
    s_mul_i32 s13, s11, 1376
    s_mul_i32 s14, s11, s15
    buffer_load_dwordx4 v3, s[48:51], s13 offen lds
    s_add_u32 m0, s10, 33792
    s_add_u32 s11, s11, 128
    s_bitset0_b32 s11, 10
    buffer_load_dwordx4 v4, s[52:55], s14 offen lds
    s_waitcnt lgkmcnt(0)
    s_waitcnt vmcnt(4)
    s_barrier
    v_mfma_f32_32x32x16_bf16 v[112:127], v[32:35], v[240:243], v[112:127]
    v_mfma_f32_32x32x16_bf16 v[112:127], v[36:39], v[244:247], v[112:127]
    v_mfma_f32_32x32x16_bf16 v[112:127], v[40:43], v[248:251], v[112:127]
    v_mfma_f32_32x32x16_bf16 v[112:127], v[44:47], v[252:255], v[112:127]
    v_dot2c_f32_bf16 v10, s74, v240
    v_dot2c_f32_bf16 v12, v240, v240
    v_dot2c_f32_bf16 v14, v48, v240
    v_dot2c_f32_bf16 v11, s74, v241
    v_dot2c_f32_bf16 v13, v241, v241
    v_dot2c_f32_bf16 v15, v49, v241
    v_dot2c_f32_bf16 v10, s74, v242
    v_dot2c_f32_bf16 v12, v242, v242
    v_dot2c_f32_bf16 v14, v50, v242
    v_dot2c_f32_bf16 v11, s74, v243
    v_dot2c_f32_bf16 v13, v243, v243
    v_dot2c_f32_bf16 v15, v51, v243
    v_dot2c_f32_bf16 v10, s74, v244
    v_dot2c_f32_bf16 v12, v244, v244
    v_dot2c_f32_bf16 v14, v52, v244
    v_dot2c_f32_bf16 v11, s74, v245
    v_dot2c_f32_bf16 v13, v245, v245
    v_dot2c_f32_bf16 v15, v53, v245
    v_dot2c_f32_bf16 v10, s74, v246
    v_dot2c_f32_bf16 v12, v246, v246
    v_dot2c_f32_bf16 v14, v54, v246
    v_dot2c_f32_bf16 v11, s74, v247
    v_dot2c_f32_bf16 v13, v247, v247
    v_dot2c_f32_bf16 v15, v55, v247
    s_barrier
    s_branch L_p1j
L_p1v:
    ds_read_b128 v[128:131], v100 offset:0
    ds_read_b64_tr_b16 v[32:33], v104 offset:0
    ds_read_b64_tr_b16 v[34:35], v104 offset:512
    ds_read_b128 v[132:135], v101 offset:0
    ds_read_b64_tr_b16 v[36:37], v105 offset:0
    ds_read_b64_tr_b16 v[38:39], v105 offset:512
    ds_read_b128 v[136:139], v102 offset:0
    ds_read_b64_tr_b16 v[40:41], v106 offset:0
    ds_read_b64_tr_b16 v[42:43], v106 offset:512
    ds_read_b128 v[140:143], v103 offset:0
    ds_read_b64_tr_b16 v[44:45], v107 offset:0
    ds_read_b64_tr_b16 v[46:47], v107 offset:512
    ds_read_b128 v[48:51], v108 offset:0
    ds_read_b128 v[52:55], v109 offset:0
    s_add_u32 m0, s10, 32768
    s_mul_i32 s12, s11, 1536
    buffer_load_dwordx4 v96, s[40:43], s11 offen lds
    buffer_load_dwordx4 v97, s[40:43], s11 offen offset:1024 lds
    s_add_u32 m0, s9, 80896
    s_add_u32 s11, s11, 128
    s_bitset0_b32 s11, 10
    buffer_load_dwordx4 v98, s[44:47], s12 offen offset:1024 lds
    s_add_u32 m0, s10, 49152
    s_mul_i32 s12, s11, 1536
    buffer_load_dwordx4 v96, s[40:43], s11 offen lds
    buffer_load_dwordx4 v97, s[40:43], s11 offen offset:1024 lds
    s_add_u32 m0, s9, 89088
    s_add_u32 s11, s11, 128
    s_bitset0_b32 s11, 10
    buffer_load_dwordx4 v98, s[44:47], s12 offen offset:1024 lds
    s_waitcnt lgkmcnt(0)
    s_waitcnt vmcnt(8)
    s_barrier
    v_mfma_f32_32x32x16_bf16 v[112:127], v[128:131], v[32:35], 0
    v_add_u32 v251, s22, v251
    v_add_u32 v3, s16, v3
    v_mfma_f32_32x32x16_bf16 v[112:127], v[132:135], v[36:39], v[112:127]
    v_add_u32 v4, s17, v4
    s_mov_b32 s15, s31
    v_mfma_f32_32x32x16_bf16 v[112:127], v[136:139], v[40:43], v[112:127]
    v_add_u32 v2, s18, v2
    buffer_load_ushort v60, v251, s[36:39], 0 offen
    v_mfma_f32_32x32x16_bf16 v[112:127], v[140:143], v[44:47], v[112:127]
    buffer_load_ushort v61, v252, s[36:39], s23 offen
    buffer_load_ushort v62, v252, s[76:79], s24 offen
    v_dot2c_f32_bf16 v10, s74, v128
    v_dot2c_f32_bf16 v12, v128, v128
    v_dot2c_f32_bf16 v14, v48, v128
    v_dot2c_f32_bf16 v11, s74, v129
    v_dot2c_f32_bf16 v13, v129, v129
    v_dot2c_f32_bf16 v15, v49, v129
    v_dot2c_f32_bf16 v10, s74, v130
    v_dot2c_f32_bf16 v12, v130, v130
    v_dot2c_f32_bf16 v14, v50, v130
    v_dot2c_f32_bf16 v11, s74, v131
    v_dot2c_f32_bf16 v13, v131, v131
    v_dot2c_f32_bf16 v15, v51, v131
    v_dot2c_f32_bf16 v10, s74, v132
    v_dot2c_f32_bf16 v12, v132, v132
    v_dot2c_f32_bf16 v14, v52, v132
    v_dot2c_f32_bf16 v11, s74, v133
    v_dot2c_f32_bf16 v13, v133, v133
    v_dot2c_f32_bf16 v15, v53, v133
    v_dot2c_f32_bf16 v10, s74, v134
    v_dot2c_f32_bf16 v12, v134, v134
    v_dot2c_f32_bf16 v14, v54, v134
    v_dot2c_f32_bf16 v11, s74, v135
    v_dot2c_f32_bf16 v13, v135, v135
    v_dot2c_f32_bf16 v15, v55, v135
    s_barrier
    ds_read_b128 v[144:147], v100 offset:16384
    ds_read_b64_tr_b16 v[32:33], v104 offset:8192
    ds_read_b64_tr_b16 v[34:35], v104 offset:8704
    ds_read_b128 v[148:151], v101 offset:16384
    ds_read_b64_tr_b16 v[36:37], v105 offset:8192
    ds_read_b64_tr_b16 v[38:39], v105 offset:8704
    ds_read_b128 v[152:155], v102 offset:16384
    ds_read_b64_tr_b16 v[40:41], v106 offset:8192
    ds_read_b64_tr_b16 v[42:43], v106 offset:8704
    ds_read_b128 v[156:159], v103 offset:16384
    ds_read_b64_tr_b16 v[44:45], v107 offset:8192
    ds_read_b64_tr_b16 v[46:47], v107 offset:8704
    ds_read_b128 v[48:51], v108 offset:128
    ds_read_b128 v[52:55], v109 offset:128
    s_cmp_lg_u32 s4, 0
    s_cbranch_scc1 L_pf_12
    s_mul_i32 s3, s2, 5504
    v_min_u32 v58, 42, v0
    v_lshlrev_b32 v58, 7, v58
    buffer_load_dword v31, v58, s[48:51], s3 offen offset:0
    s_branch L_pfe_11
L_pf_12:
    s_cmp_lg_u32 s4, 1
    s_cbranch_scc1 L_pf_13
    s_mul_i32 s3, s2, 6144
    v_min_u32 v58, 1, v240
    v_mul_u32_u24 v58, 24, v58
    v_add_lshl_u32 v58, v58, v241, 7
    buffer_load_dword v31, v58, s[44:47], s3 offen offset:0
    s_branch L_pfe_11
L_pf_13:
    buffer_load_dword v31, off, s[32:35], 0
L_pfe_11:
    s_nop 0
    s_add_u32 m0, s10, 0
    s_mul_i32 s12, s11, 1536
    buffer_load_dwordx4 v96, s[40:43], s11 offen lds
    buffer_load_dwordx4 v97, s[40:43], s11 offen offset:1024 lds
    s_add_u32 m0, s9, 64512
    s_add_u32 s11, s11, 128
    s_bitset0_b32 s11, 10
    buffer_load_dwordx4 v98, s[44:47], s12 offen offset:1024 lds
    s_waitcnt lgkmcnt(0)
    s_waitcnt vmcnt(10)
    s_barrier
    v_mfma_f32_32x32x16_bf16 v[112:127], v[144:147], v[32:35], v[112:127]
    buffer_load_ushort v63, v252, s[76:79], s24 offen offset:64
    v_add_u32 v24, s19, v24
    v_mfma_f32_32x32x16_bf16 v[112:127], v[148:151], v[36:39], v[112:127]
    v_add_u32 v16, s20, v16
    v_add_u32 v17, s21, v17
    v_mfma_f32_32x32x16_bf16 v[112:127], v[152:155], v[40:43], v[112:127]
    v_cndmask_b32 v16, v16, v17, vcc
    v_add_u32 v20, v16, v20
    v_mfma_f32_32x32x16_bf16 v[112:127], v[156:159], v[44:47], v[112:127]
    v_xor_b32 v17, 4096, v16
    v_xor_b32 v18, 8192, v16
    v_dot2c_f32_bf16 v10, s74, v144
    v_dot2c_f32_bf16 v12, v144, v144
    v_dot2c_f32_bf16 v14, v48, v144
    v_dot2c_f32_bf16 v11, s74, v145
    v_dot2c_f32_bf16 v13, v145, v145
    v_dot2c_f32_bf16 v15, v49, v145
    v_dot2c_f32_bf16 v10, s74, v146
    v_dot2c_f32_bf16 v12, v146, v146
    v_dot2c_f32_bf16 v14, v50, v146
    v_dot2c_f32_bf16 v11, s74, v147
    v_dot2c_f32_bf16 v13, v147, v147
    v_dot2c_f32_bf16 v15, v51, v147
    v_dot2c_f32_bf16 v10, s74, v148
    v_dot2c_f32_bf16 v12, v148, v148
    v_dot2c_f32_bf16 v14, v52, v148
    v_dot2c_f32_bf16 v11, s74, v149
    v_dot2c_f32_bf16 v13, v149, v149
    v_dot2c_f32_bf16 v15, v53, v149
    v_dot2c_f32_bf16 v10, s74, v150
    v_dot2c_f32_bf16 v12, v150, v150
    v_dot2c_f32_bf16 v14, v54, v150
    v_dot2c_f32_bf16 v11, s74, v151
    v_dot2c_f32_bf16 v13, v151, v151
    v_dot2c_f32_bf16 v15, v55, v151
    s_barrier
    ds_read_b128 v[160:163], v100 offset:32768
    ds_read_b64_tr_b16 v[32:33], v104 offset:16384
    ds_read_b64_tr_b16 v[34:35], v104 offset:16896
    ds_read_b128 v[164:167], v101 offset:32768
    ds_read_b64_tr_b16 v[36:37], v105 offset:16384
    ds_read_b64_tr_b16 v[38:39], v105 offset:16896
    ds_read_b128 v[168:171], v102 offset:32768
    ds_read_b64_tr_b16 v[40:41], v106 offset:16384
    ds_read_b64_tr_b16 v[42:43], v106 offset:16896
    ds_read_b128 v[172:175], v103 offset:32768
    ds_read_b64_tr_b16 v[44:45], v107 offset:16384
    ds_read_b64_tr_b16 v[46:47], v107 offset:16896
    ds_read_b128 v[48:51], v108 offset:256
    ds_read_b128 v[52:55], v109 offset:256
    s_add_u32 m0, s10, 16384
    s_mul_i32 s12, s11, 1536
    buffer_load_dwordx4 v96, s[40:43], s11 offen lds
    buffer_load_dwordx4 v97, s[40:43], s11 offen offset:1024 lds
    s_add_u32 m0, s9, 72704
    s_add_u32 s11, s11, 128
    s_bitset0_b32 s11, 10
    buffer_load_dwordx4 v98, s[44:47], s12 offen offset:1024 lds
    v_readfirstlane_b32 s100, v99
    s_nop 0
    s_add_u32 s100, s100, 1
    s_xor_b32 s101, s100, 0x5bd1e995
    s_waitcnt lgkmcnt(0)
    s_waitcnt vmcnt(11)
    s_barrier
    v_mfma_f32_32x32x16_bf16 v[112:127], v[160:163], v[32:35], v[112:127]
    v_xor_b32 v19, 12288, v16
    v_xor_b32 v21, 4096, v20
    v_mfma_f32_32x32x16_bf16 v[112:127], v[164:167], v[36:39], v[112:127]
    v_xor_b32 v22, 8192, v20
    v_xor_b32 v23, 12288, v20
    v_mfma_f32_32x32x16_bf16 v[112:127], v[168:171], v[40:43], v[112:127]
    v_xor_b32 v25, 4096, v24
    v_xor_b32 v26, 8192, v24
    v_mfma_f32_32x32x16_bf16 v[112:127], v[172:175], v[44:47], v[112:127]
    v_xor_b32 v27, 12288, v24
    v_add_u32 v8, s25, v1
    v_dot2c_f32_bf16 v10, s74, v160
    v_dot2c_f32_bf16 v12, v160, v160
    v_dot2c_f32_bf16 v14, v48, v160
    v_dot2c_f32_bf16 v11, s74, v161
    v_dot2c_f32_bf16 v13, v161, v161
    v_dot2c_f32_bf16 v15, v49, v161
    v_dot2c_f32_bf16 v10, s74, v162
    v_dot2c_f32_bf16 v12, v162, v162
    v_dot2c_f32_bf16 v14, v50, v162
    v_dot2c_f32_bf16 v11, s74, v163
    v_dot2c_f32_bf16 v13, v163, v163
    v_dot2c_f32_bf16 v15, v51, v163
    v_dot2c_f32_bf16 v10, s74, v164
    v_dot2c_f32_bf16 v12, v164, v164
    v_dot2c_f32_bf16 v14, v52, v164
    v_dot2c_f32_bf16 v11, s74, v165
    v_dot2c_f32_bf16 v13, v165, v165
    v_dot2c_f32_bf16 v15, v53, v165
    v_dot2c_f32_bf16 v10, s74, v166
    v_dot2c_f32_bf16 v12, v166, v166
    v_dot2c_f32_bf16 v14, v54, v166
    v_dot2c_f32_bf16 v11, s74, v167
    v_dot2c_f32_bf16 v13, v167, v167
    v_dot2c_f32_bf16 v15, v55, v167
    s_barrier
    ds_read_b128 v[176:179], v100 offset:49152
    ds_read_b64_tr_b16 v[32:33], v104 offset:24576
    ds_read_b64_tr_b16 v[34:35], v104 offset:25088
    ds_read_b128 v[180:183], v101 offset:49152
    ds_read_b64_tr_b16 v[36:37], v105 offset:24576
    ds_read_b64_tr_b16 v[38:39], v105 offset:25088
    ds_read_b128 v[184:187], v102 offset:49152
    ds_read_b64_tr_b16 v[40:41], v106 offset:24576
    ds_read_b64_tr_b16 v[42:43], v106 offset:25088
    ds_read_b128 v[188:191], v103 offset:49152
    ds_read_b64_tr_b16 v[44:45], v107 offset:24576
    ds_read_b64_tr_b16 v[46:47], v107 offset:25088
    ds_read_b128 v[48:51], v108 offset:384
    ds_read_b128 v[52:55], v109 offset:384
    s_add_u32 m0, s10, 32768
    s_mul_i32 s12, s11, 1536
    buffer_load_dwordx4 v96, s[40:43], s11 offen lds
    buffer_load_dwordx4 v97, s[40:43], s11 offen offset:1024 lds
    s_add_u32 m0, s9, 80896
    s_add_u32 s11, s11, 128
    s_bitset0_b32 s11, 10
    buffer_load_dwordx4 v98, s[44:47], s12 offen offset:1024 lds
    s_waitcnt lgkmcnt(0)
    s_waitcnt vmcnt(7)
    s_barrier
    v_mfma_f32_32x32x16_bf16 v[112:127], v[176:179], v[32:35], v[112:127]
    v_add_u32 v9, s26, v9
    v_add_u32 v92, s27, v92
    v_mfma_f32_32x32x16_bf16 v[112:127], v[180:183], v[36:39], v[112:127]
    v_add_u32 v93, s29, v93
    v_add_u32 v94, s28, v94
    v_mfma_f32_32x32x16_bf16 v[112:127], v[184:187], v[40:43], v[112:127]
    v_xor_b32 v95, 64, v94
    s_mov_b32 s96, 0x0000ffff
    v_mfma_f32_32x32x16_bf16 v[112:127], v[188:191], v[44:47], v[112:127]
    s_mov_b32 s97, 0x0000ffff
    v_dot2c_f32_bf16 v10, s74, v176
    v_dot2c_f32_bf16 v12, v176, v176
    v_dot2c_f32_bf16 v14, v48, v176
    v_dot2c_f32_bf16 v11, s74, v177
    v_dot2c_f32_bf16 v13, v177, v177
    v_dot2c_f32_bf16 v15, v49, v177
    v_dot2c_f32_bf16 v10, s74, v178
    v_dot2c_f32_bf16 v12, v178, v178
    v_dot2c_f32_bf16 v14, v50, v178
    v_dot2c_f32_bf16 v11, s74, v179
    v_dot2c_f32_bf16 v13, v179, v179
    v_dot2c_f32_bf16 v15, v51, v179
    v_dot2c_f32_bf16 v10, s74, v180
    v_dot2c_f32_bf16 v12, v180, v180
    v_dot2c_f32_bf16 v14, v52, v180
    v_dot2c_f32_bf16 v11, s74, v181
    v_dot2c_f32_bf16 v13, v181, v181
    v_dot2c_f32_bf16 v15, v53, v181
    v_dot2c_f32_bf16 v10, s74, v182
    v_dot2c_f32_bf16 v12, v182, v182
    v_dot2c_f32_bf16 v14, v54, v182
    v_dot2c_f32_bf16 v11, s74, v183
    v_dot2c_f32_bf16 v13, v183, v183
    v_dot2c_f32_bf16 v15, v55, v183
    s_barrier
    ds_read_b128 v[192:195], v100 offset:0
    ds_read_b64_tr_b16 v[32:33], v104 offset:0
    ds_read_b64_tr_b16 v[34:35], v104 offset:512
    ds_read_b128 v[196:199], v101 offset:0
    ds_read_b64_tr_b16 v[36:37], v105 offset:0
    ds_read_b64_tr_b16 v[38:39], v105 offset:512
    ds_read_b128 v[200:203], v102 offset:0
    ds_read_b64_tr_b16 v[40:41], v106 offset:0
    ds_read_b64_tr_b16 v[42:43], v106 offset:512
    ds_read_b128 v[204:207], v103 offset:0
    ds_read_b64_tr_b16 v[44:45], v107 offset:0
    ds_read_b64_tr_b16 v[46:47], v107 offset:512
    ds_read_b128 v[48:51], v108 offset:512
    ds_read_b128 v[52:55], v109 offset:512
    s_add_u32 m0, s10, 49152
    s_mul_i32 s12, s11, 1536
    buffer_load_dwordx4 v96, s[40:43], s11 offen lds
    buffer_load_dwordx4 v97, s[40:43], s11 offen offset:1024 lds
    s_add_u32 m0, s9, 89088
    s_add_u32 s11, s11, 128
    s_bitset0_b32 s11, 10
    buffer_load_dwordx4 v98, s[44:47], s12 offen offset:1024 lds
    s_waitcnt lgkmcnt(0)
    s_waitcnt vmcnt(6)
    s_barrier
    v_mfma_f32_32x32x16_bf16 v[112:127], v[192:195], v[32:35], v[112:127]
    v_mfma_f32_32x32x16_bf16 v[112:127], v[196:199], v[36:39], v[112:127]
    v_mfma_f32_32x32x16_bf16 v[112:127], v[200:203], v[40:43], v[112:127]
    v_mfma_f32_32x32x16_bf16 v[112:127], v[204:207], v[44:47], v[112:127]
    v_dot2c_f32_bf16 v10, s74, v192
    v_dot2c_f32_bf16 v12, v192, v192
    v_dot2c_f32_bf16 v14, v48, v192
    v_dot2c_f32_bf16 v11, s74, v193
    v_dot2c_f32_bf16 v13, v193, v193
    v_dot2c_f32_bf16 v15, v49, v193
    v_dot2c_f32_bf16 v10, s74, v194
    v_dot2c_f32_bf16 v12, v194, v194
    v_dot2c_f32_bf16 v14, v50, v194
    v_dot2c_f32_bf16 v11, s74, v195
    v_dot2c_f32_bf16 v13, v195, v195
    v_dot2c_f32_bf16 v15, v51, v195
    v_dot2c_f32_bf16 v10, s74, v196
    v_dot2c_f32_bf16 v12, v196, v196
    v_dot2c_f32_bf16 v14, v52, v196
    v_dot2c_f32_bf16 v11, s74, v197
    v_dot2c_f32_bf16 v13, v197, v197
    v_dot2c_f32_bf16 v15, v53, v197
    v_dot2c_f32_bf16 v10, s74, v198
    v_dot2c_f32_bf16 v12, v198, v198
    v_dot2c_f32_bf16 v14, v54, v198
    v_dot2c_f32_bf16 v11, s74, v199
    v_dot2c_f32_bf16 v13, v199, v199
    v_dot2c_f32_bf16 v15, v55, v199
    s_barrier
    ds_read_b128 v[208:211], v100 offset:16384
    ds_read_b64_tr_b16 v[32:33], v104 offset:8192
    ds_read_b64_tr_b16 v[34:35], v104 offset:8704
    ds_read_b128 v[212:215], v101 offset:16384
    ds_read_b64_tr_b16 v[36:37], v105 offset:8192
    ds_read_b64_tr_b16 v[38:39], v105 offset:8704
    ds_read_b128 v[216:219], v102 offset:16384
    ds_read_b64_tr_b16 v[40:41], v106 offset:8192
    ds_read_b64_tr_b16 v[42:43], v106 offset:8704
    ds_read_b128 v[220:223], v103 offset:16384
    ds_read_b64_tr_b16 v[44:45], v107 offset:8192
    ds_read_b64_tr_b16 v[46:47], v107 offset:8704
    ds_read_b128 v[48:51], v108 offset:640
    ds_read_b128 v[52:55], v109 offset:640
    s_add_u32 m0, s10, 0
    s_mul_i32 s13, s11, 1376
    s_mul_i32 s14, s11, s15
    buffer_load_dwordx4 v3, s[48:51], s13 offen lds
    s_add_u32 m0, s10, 1024
    s_add_u32 s11, s11, 128
    s_bitset0_b32 s11, 10
    buffer_load_dwordx4 v4, s[52:55], s14 offen lds
    s_waitcnt lgkmcnt(0)
    s_waitcnt vmcnt(5)
    s_barrier
    v_mfma_f32_32x32x16_bf16 v[112:127], v[208:211], v[32:35], v[112:127]
    v_mfma_f32_32x32x16_bf16 v[112:127], v[212:215], v[36:39], v[112:127]
    v_mfma_f32_32x32x16_bf16 v[112:127], v[216:219], v[40:43], v[112:127]
    v_mfma_f32_32x32x16_bf16 v[112:127], v[220:223], v[44:47], v[112:127]
    s_getpc_b64 s[0:1]
L_pc_14:
    s_add_u32 s0, s0, L_masks-L_pc_14
    s_addc_u32 s1, s1, 0
    s_load_dwordx16 s[16:31], s[0:1], 0
    s_load_dwordx16 s[32:47], s[0:1], 64
    v_dot2c_f32_bf16 v10, s74, v208
    v_dot2c_f32_bf16 v12, v208, v208
    v_dot2c_f32_bf16 v14, v48, v208
    v_dot2c_f32_bf16 v11, s74, v209
    v_dot2c_f32_bf16 v13, v209, v209
    v_dot2c_f32_bf16 v15, v49, v209
    v_dot2c_f32_bf16 v10, s74, v210
    v_dot2c_f32_bf16 v12, v210, v210
    v_dot2c_f32_bf16 v14, v50, v210
    v_dot2c_f32_bf16 v11, s74, v211
    v_dot2c_f32_bf16 v13, v211, v211
    v_dot2c_f32_bf16 v15, v51, v211
    v_dot2c_f32_bf16 v10, s74, v212
    v_dot2c_f32_bf16 v12, v212, v212
    v_dot2c_f32_bf16 v14, v52, v212
    v_dot2c_f32_bf16 v11, s74, v213
    v_dot2c_f32_bf16 v13, v213, v213
    v_dot2c_f32_bf16 v15, v53, v213
    v_dot2c_f32_bf16 v10, s74, v214
    v_dot2c_f32_bf16 v12, v214, v214
    v_dot2c_f32_bf16 v14, v54, v214
    v_dot2c_f32_bf16 v11, s74, v215
    v_dot2c_f32_bf16 v13, v215, v215
    v_dot2c_f32_bf16 v15, v55, v215
    s_barrier
    ds_read_b128 v[224:227], v100 offset:32768
    ds_read_b64_tr_b16 v[32:33], v104 offset:16384
    ds_read_b64_tr_b16 v[34:35], v104 offset:16896
    ds_read_b128 v[228:231], v101 offset:32768
    ds_read_b64_tr_b16 v[36:37], v105 offset:16384
    ds_read_b64_tr_b16 v[38:39], v105 offset:16896
    ds_read_b128 v[232:235], v102 offset:32768
    ds_read_b64_tr_b16 v[40:41], v106 offset:16384
    ds_read_b64_tr_b16 v[42:43], v106 offset:16896
    ds_read_b128 v[236:239], v103 offset:32768
    ds_read_b64_tr_b16 v[44:45], v107 offset:16384
    ds_read_b64_tr_b16 v[46:47], v107 offset:16896
    ds_read_b128 v[48:51], v108 offset:768
    ds_read_b128 v[52:55], v109 offset:768
    s_add_u32 m0, s10, 16384
    s_mul_i32 s13, s11, 1376
    s_mul_i32 s14, s11, s15
    buffer_load_dwordx4 v3, s[48:51], s13 offen lds
    s_add_u32 m0, s10, 17408
    s_add_u32 s11, s11, 128
    s_bitset0_b32 s11, 10
    buffer_load_dwordx4 v4, s[52:55], s14 offen lds
    s_waitcnt lgkmcnt(0)
    s_waitcnt vmcnt(4)
    s_barrier
    v_mfma_f32_32x32x16_bf16 v[112:127], v[224:227], v[32:35], v[112:127]
    s_waitcnt vmcnt(13)
    v_mfma_f32_32x32x16_bf16 v[112:127], v[228:231], v[36:39], v[112:127]
    v_lshl_or_b32 v5, v61, 16, v60
    v_mfma_f32_32x32x16_bf16 v[112:127], v[232:235], v[40:43], v[112:127]
    v_lshl_or_b32 v6, v63, 16, v62
    v_mfma_f32_32x32x16_bf16 v[112:127], v[236:239], v[44:47], v[112:127]
    v_dot2c_f32_bf16 v10, s74, v224
    v_dot2c_f32_bf16 v12, v224, v224
    v_dot2c_f32_bf16 v14, v48, v224
    v_dot2c_f32_bf16 v11, s74, v225
    v_dot2c_f32_bf16 v13, v225, v225
    v_dot2c_f32_bf16 v15, v49, v225
    v_dot2c_f32_bf16 v10, s74, v226
    v_dot2c_f32_bf16 v12, v226, v226
    v_dot2c_f32_bf16 v14, v50, v226
    v_dot2c_f32_bf16 v11, s74, v227
    v_dot2c_f32_bf16 v13, v227, v227
    v_dot2c_f32_bf16 v15, v51, v227
    v_dot2c_f32_bf16 v10, s74, v228
    v_dot2c_f32_bf16 v12, v228, v228
    v_dot2c_f32_bf16 v14, v52, v228
    v_dot2c_f32_bf16 v11, s74, v229
    v_dot2c_f32_bf16 v13, v229, v229
    v_dot2c_f32_bf16 v15, v53, v229
    v_dot2c_f32_bf16 v10, s74, v230
    v_dot2c_f32_bf16 v12, v230, v230
    v_dot2c_f32_bf16 v14, v54, v230
    v_dot2c_f32_bf16 v11, s74, v231
    v_dot2c_f32_bf16 v13, v231, v231
    v_dot2c_f32_bf16 v15, v55, v231
    s_barrier
    ds_read_b128 v[240:243], v100 offset:49152
    ds_read_b64_tr_b16 v[32:33], v104 offset:24576
    ds_read_b64_tr_b16 v[34:35], v104 offset:25088
    ds_read_b128 v[244:247], v101 offset:49152
    ds_read_b64_tr_b16 v[36:37], v105 offset:24576
    ds_read_b64_tr_b16 v[38:39], v105 offset:25088
    ds_read_b128 v[248:251], v102 offset:49152
    ds_read_b64_tr_b16 v[40:41], v106 offset:24576
    ds_read_b64_tr_b16 v[42:43], v106 offset:25088
    ds_read_b128 v[252:255], v103 offset:49152
    ds_read_b64_tr_b16 v[44:45], v107 offset:24576
    ds_read_b64_tr_b16 v[46:47], v107 offset:25088
    ds_read_b128 v[48:51], v108 offset:896
    ds_read_b128 v[52:55], v109 offset:896
    s_add_u32 m0, s10, 32768
    s_mul_i32 s13, s11, 1376
    s_mul_i32 s14, s11, s15
    buffer_load_dwordx4 v3, s[48:51], s13 offen lds
    s_add_u32 m0, s10, 33792
    s_add_u32 s11, s11, 128
    s_bitset0_b32 s11, 10
    buffer_load_dwordx4 v4, s[52:55], s14 offen lds
    s_waitcnt lgkmcnt(0)
    s_waitcnt vmcnt(4)
    s_barrier
    v_mfma_f32_32x32x16_bf16 v[112:127], v[240:243], v[32:35], v[112:127]
    v_mfma_f32_32x32x16_bf16 v[112:127], v[244:247], v[36:39], v[112:127]
    v_mfma_f32_32x32x16_bf16 v[112:127], v[248:251], v[40:43], v[112:127]
    v_mfma_f32_32x32x16_bf16 v[112:127], v[252:255], v[44:47], v[112:127]
    v_dot2c_f32_bf16 v10, s74, v240
    v_dot2c_f32_bf16 v12, v240, v240
    v_dot2c_f32_bf16 v14, v48, v240
    v_dot2c_f32_bf16 v11, s74, v241
    v_dot2c_f32_bf16 v13, v241, v241
    v_dot2c_f32_bf16 v15, v49, v241
    v_dot2c_f32_bf16 v10, s74, v242
    v_dot2c_f32_bf16 v12, v242, v242
    v_dot2c_f32_bf16 v14, v50, v242
    v_dot2c_f32_bf16 v11, s74, v243
    v_dot2c_f32_bf16 v13, v243, v243
    v_dot2c_f32_bf16 v15, v51, v243
    v_dot2c_f32_bf16 v10, s74, v244
    v_dot2c_f32_bf16 v12, v244, v244
    v_dot2c_f32_bf16 v14, v52, v244
    v_dot2c_f32_bf16 v11, s74, v245
    v_dot2c_f32_bf16 v13, v245, v245
    v_dot2c_f32_bf16 v15, v53, v245
    v_dot2c_f32_bf16 v10, s74, v246
    v_dot2c_f32_bf16 v12, v246, v246
    v_dot2c_f32_bf16 v14, v54, v246
    v_dot2c_f32_bf16 v11, s74, v247
    v_dot2c_f32_bf16 v13, v247, v247
    v_dot2c_f32_bf16 v15, v55, v247
    s_barrier
L_p1j:
    ds_read_b64_tr_b16 v[32:33], v16 offset:0
    ds_read_b64_tr_b16 v[34:35], v20 offset:0
    ds_read_b64_tr_b16 v[36:37], v24 offset:0
    ds_read_b64_tr_b16 v[38:39], v24 offset:768
    ds_read_b64_tr_b16 v[40:41], v17 offset:0
    ds_read_b64_tr_b16 v[42:43], v21 offset:0
    ds_read_b64_tr_b16 v[44:45], v25 offset:0
    ds_read_b64_tr_b16 v[46:47], v25 offset:768
    ds_read_b64_tr_b16 v[48:49], v18 offset:0
    ds_read_b64_tr_b16 v[50:51], v22 offset:0
    ds_read_b64_tr_b16 v[52:53], v26 offset:0
    ds_read_b64_tr_b16 v[54:55], v26 offset:768
    ds_read_b64_tr_b16 v[56:57], v19 offset:0
    ds_read_b64_tr_b16 v[58:59], v23 offset:0
    ds_read_b64_tr_b16 v[60:61], v27 offset:0
    ds_read_b64_tr_b16 v[62:63], v27 offset:768
    v_cvt_pk_bf16_f32 v96, v112, v113
    v_cvt_pk_bf16_f32 v97, v114, v115
    v_cvt_pk_bf16_f32 v98, v116, v117
    v_cvt_pk_bf16_f32 v99, v118, v119
    v_cvt_pk_bf16_f32 v100, v120, v121
    v_cvt_pk_bf16_f32 v101, v122, v123
    v_cvt_pk_bf16_f32 v102, v124, v125
    v_cvt_pk_bf16_f32 v103, v126, v127
    buffer_store_dwordx4 v[96:99], v1, s[64:67], s80 offen sc1
    buffer_store_dwordx4 v[100:103], v1, s[64:67], s81 offen sc1
    s_add_u32 m0, s10, 49152
    s_mul_i32 s13, s11, 1376
    s_mul_i32 s14, s11, s15
    buffer_load_dwordx4 v3, s[48:51], s13 offen lds
    s_add_u32 m0, s10, 50176
    s_add_u32 s11, s11, 128
    s_bitset0_b32 s11, 10
    buffer_load_dwordx4 v4, s[52:55], s14 offen lds
    s_waitcnt lgkmcnt(0)
    s_waitcnt vmcnt(6)
    s_barrier
    v_mfma_f32_32x32x16_bf16 v[96:111], v[32:35], v[128:131], 0
    v_add_f32 v10, v10, v11
    v_add_f32 v11, v12, v13
    v_add_f32 v12, v14, v15
    v_mfma_f32_32x32x16_bf16 v[112:127], v[36:39], v[128:131], 0
    v_and_b32 v28, 0x1f0, v1
    s_lshl_b32 s3, s4, 9
    s_add_u32 s3, s3, 156672
    v_mfma_f32_32x32x16_bf16 v[96:111], v[40:43], v[132:135], v[96:111]
    v_add_u32 v29, s3, v28
    v_mov_b32 v13, v10
    v_mfma_f32_32x32x16_bf16 v[112:127], v[44:47], v[132:135], v[112:127]
    v_mov_b32 v14, v11
    v_mov_b32 v15, v12
    s_xor_b32 s3, s4, 4
    v_mfma_f32_32x32x16_bf16 v[96:111], v[48:51], v[136:139], v[96:111]
    s_lshl_b32 s3, s3, 9
    s_add_u32 s3, s3, 156672
    v_add_u32 v28, s3, v28
    v_mfma_f32_32x32x16_bf16 v[112:127], v[52:55], v[136:139], v[112:127]
    v_permlane32_swap_b32 v10, v13
    v_permlane32_swap_b32 v11, v14
    v_mfma_f32_32x32x16_bf16 v[96:111], v[56:59], v[140:143], v[96:111]
    v_permlane32_swap_b32 v12, v15
    v_add_f32 v10, v10, v13
    v_add_f32 v11, v11, v14
    v_mfma_f32_32x32x16_bf16 v[112:127], v[60:63], v[140:143], v[112:127]
    v_add_f32 v12, v12, v15
    ds_write_b128 v29, v[10:13]
    v_mfma_f32_16x16x32_bf16 v[64:67], v[72:75], v[32:35], 0
    v_mfma_f32_16x16x32_bf16 v[68:71], v[72:75], v[36:39], 0
    s_barrier
    ds_read_b64_tr_b16 v[32:33], v16 offset:16384
    ds_read_b64_tr_b16 v[34:35], v20 offset:16384
    ds_read_b64_tr_b16 v[36:37], v24 offset:16384
    ds_read_b64_tr_b16 v[38:39], v24 offset:17152
    ds_read_b64_tr_b16 v[40:41], v17 offset:16384
    ds_read_b64_tr_b16 v[42:43], v21 offset:16384
    ds_read_b64_tr_b16 v[44:45], v25 offset:16384
    ds_read_b64_tr_b16 v[46:47], v25 offset:17152
    ds_read_b64_tr_b16 v[48:49], v18 offset:16384
    ds_read_b64_tr_b16 v[50:51], v22 offset:16384
    ds_read_b64_tr_b16 v[52:53], v26 offset:16384
    ds_read_b64_tr_b16 v[54:55], v26 offset:17152
    ds_read_b64_tr_b16 v[56:57], v19 offset:16384
    ds_read_b64_tr_b16 v[58:59], v23 offset:16384
    ds_read_b64_tr_b16 v[60:61], v27 offset:16384
    ds_read_b64_tr_b16 v[62:63], v27 offset:17152
    s_add_u32 m0, s10, 0
    s_mul_i32 s13, s11, 1376
    s_mul_i32 s14, s11, s15
    buffer_load_dwordx4 v3, s[48:51], s13 offen lds
    s_add_u32 m0, s10, 1024
    s_add_u32 s11, s11, 128
    s_bitset0_b32 s11, 10
    buffer_load_dwordx4 v4, s[52:55], s14 offen lds
    s_waitcnt lgkmcnt(0)
    s_waitcnt vmcnt(6)
    s_barrier
    v_mfma_f32_32x32x16_bf16 v[96:111], v[32:35], v[144:147], v[96:111]
    s_waitcnt vmcnt(4)
    v_mfma_f32_32x32x16_bf16 v[112:127], v[36:39], v[144:147], v[112:127]
    v_mfma_f32_32x32x16_bf16 v[96:111], v[40:43], v[148:151], v[96:111]
    v_mov_b64 v[128:129], s[100:101]
    v_mfma_f32_32x32x16_bf16 v[112:127], v[44:47], v[148:151], v[112:127]
    v_mfma_f32_32x32x16_bf16 v[96:111], v[48:51], v[152:155], v[96:111]
    v_mfma_f32_32x32x16_bf16 v[112:127], v[52:55], v[152:155], v[112:127]
    s_mov_b64 exec, 1
    buffer_store_dwordx2 v[128:129], off, s[64:67], s82 sc1
    s_mov_b64 exec, -1
    v_mfma_f32_32x32x16_bf16 v[96:111], v[56:59], v[156:159], v[96:111]
    v_mfma_f32_32x32x16_bf16 v[112:127], v[60:63], v[156:159], v[112:127]
    v_mfma_f32_16x16x32_bf16 v[64:67], v[72:75], v[32:35], v[64:67]
    v_mfma_f32_16x16x32_bf16 v[68:71], v[72:75], v[36:39], v[68:71]
    s_barrier
    ds_read_b64_tr_b16 v[32:33], v16 offset:32768
    ds_read_b64_tr_b16 v[34:35], v20 offset:32768
    ds_read_b64_tr_b16 v[36:37], v24 offset:32768
    ds_read_b64_tr_b16 v[38:39], v24 offset:33536
    ds_read_b64_tr_b16 v[40:41], v17 offset:32768
    ds_read_b64_tr_b16 v[42:43], v21 offset:32768
    ds_read_b64_tr_b16 v[44:45], v25 offset:32768
    ds_read_b64_tr_b16 v[46:47], v25 offset:33536
    ds_read_b64_tr_b16 v[48:49], v18 offset:32768
    ds_read_b64_tr_b16 v[50:51], v22 offset:32768
    ds_read_b64_tr_b16 v[52:53], v26 offset:32768
    ds_read_b64_tr_b16 v[54:55], v26 offset:33536
    ds_read_b64_tr_b16 v[56:57], v19 offset:32768
    ds_read_b64_tr_b16 v[58:59], v23 offset:32768
    ds_read_b64_tr_b16 v[60:61], v27 offset:32768
    ds_read_b64_tr_b16 v[62:63], v27 offset:33536
    s_add_u32 m0, s10, 16384
    s_mul_i32 s13, s11, 1376
    s_mul_i32 s14, s11, s15
    buffer_load_dwordx4 v3, s[48:51], s13 offen lds
    s_add_u32 m0, s10, 17408
    s_add_u32 s11, s11, 128
    s_bitset0_b32 s11, 10
    buffer_load_dwordx4 v4, s[52:55], s14 offen lds
    s_waitcnt lgkmcnt(0)
    s_waitcnt vmcnt(5)
    s_barrier
    v_mfma_f32_32x32x16_bf16 v[96:111], v[32:35], v[160:163], v[96:111]
    ds_read_b128 v[28:31], v28
    v_mfma_f32_32x32x16_bf16 v[112:127], v[36:39], v[160:163], v[112:127]
    v_mfma_f32_32x32x16_bf16 v[96:111], v[40:43], v[164:167], v[96:111]
    v_mfma_f32_32x32x16_bf16 v[112:127], v[44:47], v[164:167], v[112:127]
    v_mfma_f32_32x32x16_bf16 v[96:111], v[48:51], v[168:171], v[96:111]
    v_mfma_f32_32x32x16_bf16 v[112:127], v[52:55], v[168:171], v[112:127]
    v_mfma_f32_32x32x16_bf16 v[96:111], v[56:59], v[172:175], v[96:111]
    v_mfma_f32_32x32x16_bf16 v[112:127], v[60:63], v[172:175], v[112:127]
    v_mfma_f32_16x16x32_bf16 v[64:67], v[72:75], v[32:35], v[64:67]
    v_mfma_f32_16x16x32_bf16 v[68:71], v[72:75], v[36:39], v[68:71]
    s_barrier
    ds_read_b64_tr_b16 v[32:33], v16 offset:49152
    ds_read_b64_tr_b16 v[34:35], v20 offset:49152
    ds_read_b64_tr_b16 v[36:37], v24 offset:49152
    ds_read_b64_tr_b16 v[38:39], v24 offset:49920
    ds_read_b64_tr_b16 v[40:41], v17 offset:49152
    ds_read_b64_tr_b16 v[42:43], v21 offset:49152
    ds_read_b64_tr_b16 v[44:45], v25 offset:49152
    ds_read_b64_tr_b16 v[46:47], v25 offset:49920
    ds_read_b64_tr_b16 v[48:49], v18 offset:49152
    ds_read_b64_tr_b16 v[50:51], v22 offset:49152
    ds_read_b64_tr_b16 v[52:53], v26 offset:49152
    ds_read_b64_tr_b16 v[54:55], v26 offset:49920
    ds_read_b64_tr_b16 v[56:57], v19 offset:49152
    ds_read_b64_tr_b16 v[58:59], v23 offset:49152
    ds_read_b64_tr_b16 v[60:61], v27 offset:49152
    ds_read_b64_tr_b16 v[62:63], v27 offset:49920
    s_add_u32 m0, s10, 32768
    s_mul_i32 s13, s11, 1376
    s_mul_i32 s14, s11, s15
    buffer_load_dwordx4 v3, s[48:51], s13 offen lds
    s_add_u32 m0, s10, 33792
    s_add_u32 s11, s11, 128
    s_bitset0_b32 s11, 10
    buffer_load_dwordx4 v4, s[52:55], s14 offen lds
    s_waitcnt lgkmcnt(0)
    s_waitcnt vmcnt(5)
    s_barrier
    v_mfma_f32_32x32x16_bf16 v[96:111], v[32:35], v[176:179], v[96:111]
    v_add_f32 v28, v10, v28
    v_add_f32 v29, v11, v29
    v_add_f32 v30, v12, v30
    v_mfma_f32_32x32x16_bf16 v[112:127], v[36:39], v[176:179], v[112:127]
    v_mul_f32 v14, 0xbb000000, v28
    v_mul_f32 v29, 0x3b000000, v29
    v_mfma_f32_32x32x16_bf16 v[96:111], v[40:43], v[180:183], v[96:111]
    v_fma_f32 v29, -v14, v14, v29
    v_max_f32 v29, 0, v29
    v_add_f32 v29, 0x3727c5ac, v29
    v_mfma_f32_32x32x16_bf16 v[112:127], v[44:47], v[180:183], v[112:127]
    v_sqrt_f32 v15, v29
    v_rsq_f32 v28, v29
    v_mfma_f32_32x32x16_bf16 v[96:111], v[48:51], v[184:187], v[96:111]
    v_mul_f32 v30, 0x3fb8aa3b, v30
    v_exp_f32 v29, -v30
    v_exp_f32 v30, v30
    v_mfma_f32_32x32x16_bf16 v[112:127], v[52:55], v[184:187], v[112:127]
    v_mul_f32 v10, 0xc0135761, v28
    v_mul_f32 v11, v28, v28
    v_mfma_f32_32x32x16_bf16 v[96:111], v[56:59], v[188:191], v[96:111]
    v_mul_f32 v11, v11, v28
    v_mul_f32 v11, 0xbdd2d3e8, v11
    v_add_f32 v29, 1.0, v29
    v_mfma_f32_32x32x16_bf16 v[112:127], v[60:63], v[188:191], v[112:127]
    v_min_f32 v30, 0x7149f2ca, v30
    v_add_f32 v30, 1.0, v30
    v_mfma_f32_16x16x32_bf16 v[64:67], v[72:75], v[32:35], v[64:67]
    v_mfma_f32_16x16x32_bf16 v[68:71], v[72:75], v[36:39], v[68:71]
    s_barrier
    ds_read_b64_tr_b16 v[32:33], v16 offset:0
    ds_read_b64_tr_b16 v[34:35], v20 offset:0
    ds_read_b64_tr_b16 v[36:37], v24 offset:0
    ds_read_b64_tr_b16 v[38:39], v24 offset:768
    ds_read_b64_tr_b16 v[40:41], v17 offset:0
    ds_read_b64_tr_b16 v[42:43], v21 offset:0
    ds_read_b64_tr_b16 v[44:45], v25 offset:0
    ds_read_b64_tr_b16 v[46:47], v25 offset:768
    ds_read_b64_tr_b16 v[48:49], v18 offset:0
    ds_read_b64_tr_b16 v[50:51], v22 offset:0
    ds_read_b64_tr_b16 v[52:53], v26 offset:0
    ds_read_b64_tr_b16 v[54:55], v26 offset:768
    ds_read_b64_tr_b16 v[56:57], v19 offset:0
    ds_read_b64_tr_b16 v[58:59], v23 offset:0
    ds_read_b64_tr_b16 v[60:61], v27 offset:0
    ds_read_b64_tr_b16 v[62:63], v27 offset:768
    s_add_u32 m0, s10, 49152
    s_mul_i32 s13, s11, 1376
    s_mul_i32 s14, s11, s15
    buffer_load_dwordx4 v3, s[48:51], s13 offen lds
    s_add_u32 m0, s10, 50176
    s_add_u32 s11, s11, 128
    s_bitset0_b32 s11, 10
    buffer_load_dwordx4 v4, s[52:55], s14 offen lds
    s_cmp_lg_u32 s4, 0
    s_cbranch_scc1 L_pf_15
    s_mul_i32 s3, s2, 5504
    v_min_u32 v139, 42, v0
    v_lshlrev_b32 v139, 7, v139
    buffer_load_dword v31, v139, s[56:59], s3 offen
L_pf_15:
    s_cmp_lg_u32 s4, 1
    s_cbranch_scc1 L_pf_16
    s_lshr_b32 s3, s2, 3
    s_mul_i32 s3, s3, 44032
    v_min_u32 v139, 42, v0
    v_mul_u32_u24 v139, 1024, v139
    buffer_load_dword v31, v139, s[56:59], s3 offen offset:384
L_pf_16:
    s_nop 0
    s_waitcnt lgkmcnt(0)
    s_waitcnt vmcnt(4)
    s_barrier
    v_mfma_f32_32x32x16_bf16 v[96:111], v[32:35], v[192:195], v[96:111]
    v_rcp_f32 v13, v29
    v_mul_f32 v12, v15, v30
    v_rcp_f32 v30, v30
    v_lshrrev_b32 v28, 2, v1
    v_mfma_f32_32x32x16_bf16 v[112:127], v[36:39], v[192:195], v[112:127]
    v_and_b32 v28, 0x7c, v28
    s_lshl_b32 s3, s5, 7
    s_add_u32 s3, s3, 160768
    v_mfma_f32_32x32x16_bf16 v[96:111], v[40:43], v[196:199], v[96:111]
    v_add_u32 v28, s3, v28
    ds_write_b32 v28, v30
    v_cvt_pk_bf16_f32 v132, v14, v14
    v_and_b32 v132, 0xffff0000, v132
    v_mfma_f32_32x32x16_bf16 v[112:127], v[44:47], v[196:199], v[112:127]
    v_sub_f32 v133, v14, v132
    v_cvt_pk_bf16_f32 v140, v132, v133
    v_cvt_pk_bf16_f32 v134, v15, v15
    v_mfma_f32_32x32x16_bf16 v[96:111], v[48:51], v[200:203], v[96:111]
    v_and_b32 v134, 0xffff0000, v134
    v_sub_f32 v135, v15, v134
    v_cvt_pk_bf16_f32 v142, v134, v135
    v_mfma_f32_32x32x16_bf16 v[112:127], v[52:55], v[200:203], v[112:127]
    v_mov_b32 v141, v140
    v_mov_b32 v143, 0
    s_add_u32 m0, s9, 147456
    s_nop 0
    buffer_load_dwordx4 v2, s[56:59], s92 offen lds
    v_mfma_f32_32x32x16_bf16 v[96:111], v[56:59], v[204:207], v[96:111]
    s_add_u32 s92, s92, 65536
    s_cmp_eq_u32 s92, 1441792
    s_cselect_b32 s92, 0, s92
    s_add_u32 m0, s9, 65536
    v_mfma_f32_32x32x16_bf16 v[112:127], v[60:63], v[204:207], v[112:127]
    buffer_load_dwordx4 v2, s[56:59], s92 offen lds
    s_add_u32 s92, s92, 65536
    s_cmp_eq_u32 s92, 1441792
    s_cselect_b32 s92, 0, s92
    v_mfma_f32_16x16x32_bf16 v[64:67], v[72:75], v[32:35], v[64:67]
    v_mfma_f32_16x16x32_bf16 v[68:71], v[72:75], v[36:39], v[68:71]
    s_barrier
    ds_read_b64_tr_b16 v[32:33], v16 offset:16384
    ds_read_b64_tr_b16 v[34:35], v20 offset:16384
    ds_read_b64_tr_b16 v[36:37], v24 offset:16384
    ds_read_b64_tr_b16 v[38:39], v24 offset:17152
    ds_read_b64_tr_b16 v[40:41], v17 offset:16384
    ds_read_b64_tr_b16 v[42:43], v21 offset:16384
    ds_read_b64_tr_b16 v[44:45], v25 offset:16384
    ds_read_b64_tr_b16 v[46:47], v25 offset:17152
    ds_read_b64_tr_b16 v[48:49], v18 offset:16384
    ds_read_b64_tr_b16 v[50:51], v22 offset:16384
    ds_read_b64_tr_b16 v[52:53], v26 offset:16384
    ds_read_b64_tr_b16 v[54:55], v26 offset:17152
    ds_read_b64_tr_b16 v[56:57], v19 offset:16384
    ds_read_b64_tr_b16 v[58:59], v23 offset:16384
    ds_read_b64_tr_b16 v[60:61], v27 offset:16384
    ds_read_b64_tr_b16 v[62:63], v27 offset:17152
    s_waitcnt lgkmcnt(0)
    s_waitcnt vmcnt(4)
    s_barrier
    v_mfma_f32_32x32x16_bf16 v[96:111], v[32:35], v[208:211], v[96:111]
    buffer_load_dwordx2 v[136:137], v93, s[64:67], 0 offen sc1
    v_mov_b32 v138, 0xffff
    v_cndmask_b32 v160, 0, v138, s[16:17]
    v_cndmask_b32 v160, v160, -1, s[18:19]
    v_mfma_f32_32x32x16_bf16 v[112:127], v[36:39], v[208:211], v[112:127]
    v_cndmask_b32 v161, 0, v138, s[20:21]
    v_cndmask_b32 v161, v161, -1, s[22:23]
    v_cndmask_b32 v162, 0, v138, s[24:25]
    v_cndmask_b32 v162, v162, -1, s[26:27]
    v_mfma_f32_32x32x16_bf16 v[96:111], v[40:43], v[212:215], v[96:111]
    v_cndmask_b32 v163, 0, v138, s[28:29]
    v_cndmask_b32 v163, v163, -1, s[30:31]
    v_cndmask_b32 v164, 0, v138, s[32:33]
    v_cndmask_b32 v164, v164, -1, s[34:35]
    v_mfma_f32_32x32x16_bf16 v[112:127], v[44:47], v[212:215], v[112:127]
    v_cndmask_b32 v165, 0, v138, s[36:37]
    v_cndmask_b32 v165, v165, -1, s[38:39]
    v_cndmask_b32 v166, 0, v138, s[40:41]
    v_mfma_f32_32x32x16_bf16 v[96:111], v[48:51], v[216:219], v[96:111]
    v_cndmask_b32 v166, v166, -1, s[42:43]
    v_cndmask_b32 v167, 0, v138, s[44:45]
    v_cndmask_b32 v167, v167, -1, s[46:47]
    s_add_u32 m0, s9, 73728
    v_mfma_f32_32x32x16_bf16 v[112:127], v[52:55], v[216:219], v[112:127]
    buffer_load_dwordx4 v2, s[56:59], s92 offen lds
    s_add_u32 s92, s92, 65536
    s_cmp_eq_u32 s92, 1441792
    s_cselect_b32 s92, 0, s92
    s_add_u32 m0, s9, 81920
    v_mfma_f32_32x32x16_bf16 v[96:111], v[56:59], v[220:223], v[96:111]
    buffer_load_dwordx4 v2, s[56:59], s92 offen lds
    s_add_u32 s92, s92, 65536
    s_cmp_eq_u32 s92, 1441792
    s_cselect_b32 s92, 0, s92
    s_add_u32 m0, s9, 90112
    v_mfma_f32_32x32x16_bf16 v[112:127], v[60:63], v[220:223], v[112:127]
    buffer_load_dwordx4 v2, s[56:59], s92 offen lds
    s_add_u32 s92, s92, 65536
    s_cmp_eq_u32 s92, 1441792
    s_cselect_b32 s92, 0, s92
    v_mfma_f32_16x16x32_bf16 v[64:67], v[72:75], v[32:35], v[64:67]
    v_mfma_f32_16x16x32_bf16 v[68:71], v[72:75], v[36:39], v[68:71]
    s_barrier
    ds_read_b64_tr_b16 v[32:33], v16 offset:32768
    ds_read_b64_tr_b16 v[34:35], v20 offset:32768
    ds_read_b64_tr_b16 v[36:37], v24 offset:32768
    ds_read_b64_tr_b16 v[38:39], v24 offset:33536
    ds_read_b64_tr_b16 v[40:41], v17 offset:32768
    ds_read_b64_tr_b16 v[42:43], v21 offset:32768
    ds_read_b64_tr_b16 v[44:45], v25 offset:32768
    ds_read_b64_tr_b16 v[46:47], v25 offset:33536
    ds_read_b64_tr_b16 v[48:49], v18 offset:32768
    ds_read_b64_tr_b16 v[50:51], v22 offset:32768
    ds_read_b64_tr_b16 v[52:53], v26 offset:32768
    ds_read_b64_tr_b16 v[54:55], v26 offset:33536
    ds_read_b64_tr_b16 v[56:57], v19 offset:32768
    ds_read_b64_tr_b16 v[58:59], v23 offset:32768
    ds_read_b64_tr_b16 v[60:61], v27 offset:32768
    ds_read_b64_tr_b16 v[62:63], v27 offset:33536
    s_waitcnt lgkmcnt(0)
    s_waitcnt vmcnt(6)
    s_barrier
    v_mfma_f32_32x32x16_bf16 v[96:111], v[32:35], v[224:227], v[96:111]
    s_add_u32 m0, s9, 0
    s_nop 0
    buffer_load_dwordx4 v2, s[56:59], s92 offen lds
    s_add_u32 s92, s92, 65536
    v_mfma_f32_32x32x16_bf16 v[112:127], v[36:39], v[224:227], v[112:127]
    s_cmp_eq_u32 s92, 1441792
    s_cselect_b32 s92, 0, s92
    s_waitcnt vmcnt(4)
    v_cmp_ne_u64 vcc, s[100:101], v[136:137]
    v_mfma_f32_32x32x16_bf16 v[96:111], v[40:43], v[228:231], v[96:111]
    s_cbranch_vccnz L_rare_17
L_back_18:
    s_lshl_b32 s3, s4, 9
    s_add_u32 s3, s3, 156672
    v_mfma_f32_32x32x16_bf16 v[112:127], v[44:47], v[228:231], v[112:127]
    v_lshrrev_b32 v29, 1, v1
    v_add_u32 v28, s3, v29
    s_lshl_b32 s3, s6, 11
    v_mfma_f32_32x32x16_bf16 v[96:111], v[48:51], v[232:235], v[96:111]
    s_add_u32 s3, s3, 156672
    v_add_u32 v29, s3, v29
    s_waitcnt vmcnt(41)
    v_mfma_f32_32x32x16_bf16 v[112:127], v[52:55], v[232:235], v[112:127]
    v_and_b32 v154, 0xffff, v5
    v_lshl_or_b32 v154, v154, 16, v154
    v_mov_b32 v155, 0
    v_mfma_f32_32x32x16_bf16 v[96:111], v[56:59], v[236:239], v[96:111]
    v_lshrrev_b32 v158, 16, v5
    v_lshl_or_b32 v158, v158, 16, v158
    v_mov_b32 v159, 0
    v_mfma_f32_32x32x16_bf16 v[112:127], v[60:63], v[236:239], v[112:127]
    s_mov_b32 vcc_lo, 0xffff0000
    s_mov_b32 vcc_hi, 0xffff0000
    v_mfma_f32_16x16x32_bf16 v[64:67], v[72:75], v[32:35], v[64:67]
    v_mfma_f32_16x16x32_bf16 v[68:71], v[72:75], v[36:39], v[68:71]
    s_barrier
    ds_read_b64_tr_b16 v[32:33], v16 offset:49152
    ds_read_b64_tr_b16 v[34:35], v20 offset:49152
    ds_read_b64_tr_b16 v[36:37], v24 offset:49152
    ds_read_b64_tr_b16 v[38:39], v24 offset:49920
    ds_read_b64_tr_b16 v[40:41], v17 offset:49152
    ds_read_b64_tr_b16 v[42:43], v21 offset:49152
    ds_read_b64_tr_b16 v[44:45], v25 offset:49152
    ds_read_b64_tr_b16 v[46:47], v25 offset:49920
    ds_read_b64_tr_b16 v[48:49], v18 offset:49152
    ds_read_b64_tr_b16 v[50:51], v22 offset:49152
    ds_read_b64_tr_b16 v[52:53], v26 offset:49152
    ds_read_b64_tr_b16 v[54:55], v26 offset:49920
    ds_read_b64_tr_b16 v[56:57], v19 offset:49152
    ds_read_b64_tr_b16 v[58:59], v23 offset:49152
    ds_read_b64_tr_b16 v[60:61], v27 offset:49152
    ds_read_b64_tr_b16 v[62:63], v27 offset:49920
    s_waitcnt lgkmcnt(12)
    v_mfma_f32_16x16x32_bf16 v[64:67], v[72:75], v[32:35], v[64:67]
    v_mfma_f32_16x16x32_bf16 v[68:71], v[72:75], v[36:39], v[68:71]
    s_nop 6
    v_cndmask_b32 v128, v64, v65, vcc
    v_cndmask_b32 v129, v68, v69, vcc
    ds_write_b64 v28, v[128:129]
    s_waitcnt lgkmcnt(0)
    s_waitcnt vmcnt(3)
    s_barrier
    v_mfma_f32_32x32x16_bf16 v[96:111], v[32:35], v[240:243], v[96:111]
    s_add_u32 s12, s90, 0
    s_cmp_lt_i32 s91, 0
    s_cselect_b32 s12, 0x40000000, s12
    s_add_u32 m0, s75, 98304
    s_nop 0
    buffer_load_dwordx4 v1, s[64:67], s12 offen sc1 lds
    buffer_load_dwordx4 v1, s[64:67], s12 offen offset:1024 sc1 lds
    v_mfma_f32_32x32x16_bf16 v[112:127], v[36:39], v[240:243], v[112:127]
    s_add_u32 s12, s90, 2048
    s_cmp_lt_i32 s91, -2
    s_cselect_b32 s12, 0x40000000, s12
    s_add_u32 m0, s75, 100352
    s_nop 0
    buffer_load_dwordx4 v1, s[64:67], s12 offen sc1 lds
    buffer_load_dwordx4 v1, s[64:67], s12 offen offset:1024 sc1 lds
    v_mfma_f32_32x32x16_bf16 v[96:111], v[40:43], v[244:247], v[96:111]
    s_add_u32 s12, s90, 4096
    s_cmp_lt_i32 s91, -4
    s_cselect_b32 s12, 0x40000000, s12
    s_add_u32 m0, s75, 102400
    s_nop 0
    buffer_load_dwordx4 v1, s[64:67], s12 offen sc1 lds
    buffer_load_dwordx4 v1, s[64:67], s12 offen offset:1024 sc1 lds
    v_mfma_f32_32x32x16_bf16 v[112:127], v[44:47], v[244:247], v[112:127]
    ds_read_b64 v[144:145], v29 offset:0
    ds_read_b64 v[146:147], v29 offset:512
    ds_read_b64 v[148:149], v29 offset:1024
    ds_read_b64 v[150:151], v29 offset:1536
    v_mfma_f32_32x32x16_bf16 v[96:111], v[48:51], v[248:251], v[96:111]
    s_waitcnt lgkmcnt(0)
    v_add_f32 v144, v144, v146
    v_add_f32 v148, v148, v150
    v_add_f32 v145, v145, v147
    v_add_f32 v149, v149, v151
    v_mfma_f32_32x32x16_bf16 v[112:127], v[52:55], v[248:251], v[112:127]
    v_add_f32 v144, v144, v148
    v_add_f32 v145, v145, v149
    s_mov_b32 vcc_hi, 0
    v_cndmask_b32 v144, 0, v144, vcc
    s_mov_b32 vcc_lo, -1
    v_mfma_f32_32x32x16_bf16 v[96:111], v[56:59], v[252:255], v[96:111]
    v_cndmask_b32 v145, 0, v145, vcc
    v_cvt_pk_bf16_f32 v152, v144, v144
    v_and_b32 v146, 0xffff0000, v152
    v_sub_f32 v146, v144, v146
    v_cvt_pk_bf16_f32 v153, v146, v146
    v_mfma_f32_32x32x16_bf16 v[112:127], v[60:63], v[252:255], v[112:127]
    v_cvt_pk_bf16_f32 v156, v145, v145
    v_and_b32 v147, 0xffff0000, v156
    v_sub_f32 v147, v145, v147
    v_cvt_pk_bf16_f32 v157, v147, v147
    s_nop 1
    v_mfma_f32_32x32x16_bf16 v[112:127], v[156:159], v[140:143], v[112:127]
    v_mfma_f32_32x32x16_bf16 v[96:111], v[152:155], v[140:143], v[96:111]
    s_cmp_lg_u32 s6, 0
    s_cbranch_scc1 L_nostag2
    s_barrier
L_nostag2:
    s_lshl_b32 s12, s8, 1
    s_add_u32 s12, s12, s6
    ds_read_b64_tr_b16 v[248:249], v94 offset:49152
    ds_read_b64_tr_b16 v[250:251], v94 offset:50176
    ds_read_b64_tr_b16 v[252:253], v95 offset:49152
    ds_read_b64_tr_b16 v[254:255], v95 offset:50176
    s_nop 1
    v_pk_mul_f32 v[176:177], v[112:113], v[112:113]
    v_pk_mul_f32 v[178:179], v[114:115], v[114:115]
    v_pk_mul_f32 v[180:181], v[116:117], v[116:117]
    v_pk_mul_f32 v[182:183], v[118:119], v[118:119]
    v_pk_fma_f32 v[176:177], v[176:177], v[10:11], v[10:11] op_sel:[0,1,0] op_sel_hi:[1,1,0]
    v_pk_fma_f32 v[178:179], v[178:179], v[10:11], v[10:11] op_sel:[0,1,0] op_sel_hi:[1,1,0]
    v_pk_fma_f32 v[180:181], v[180:181], v[10:11], v[10:11] op_sel:[0,1,0] op_sel_hi:[1,1,0]
    v_pk_fma_f32 v[182:183], v[182:183], v[10:11], v[10:11] op_sel:[0,1,0] op_sel_hi:[1,1,0]
    v_pk_mul_f32 v[176:177], v[176:177], v[112:113]
    v_pk_mul_f32 v[178:179], v[178:179], v[114:115]
    v_pk_mul_f32 v[180:181], v[180:181], v[116:117]
    v_pk_mul_f32 v[182:183], v[182:183], v[118:119]
    s_add_u32 m0, s9, 8192
    s_nop 0
    buffer_load_dwordx4 v2, s[56:59], s92 offen lds
    s_add_u32 s92, s92, 65536
    s_cmp_eq_u32 s92, 1441792
    s_cselect_b32 s92, 0, s92
    v_exp_f32 v176, v176
    v_exp_f32 v177, v177
    v_exp_f32 v178, v178
    v_exp_f32 v179, v179
    v_exp_f32 v180, v180
    v_exp_f32 v181, v181
    v_exp_f32 v182, v182
    v_exp_f32 v183, v183
    s_add_u32 m0, s9, 16384
    s_nop 0
    buffer_load_dwordx4 v2, s[56:59], s92 offen lds
    s_add_u32 s92, s92, 65536
    s_cmp_eq_u32 s92, 1441792
    s_cselect_b32 s92, 0, s92
    v_pk_fma_f32 v[176:177], v[176:177], v[12:13], v[12:13] op_sel_hi:[1,0,0]
    v_pk_fma_f32 v[178:179], v[178:179], v[12:13], v[12:13] op_sel_hi:[1,0,0]
    v_pk_fma_f32 v[180:181], v[180:181], v[12:13], v[12:13] op_sel_hi:[1,0,0]
    v_pk_fma_f32 v[182:183], v[182:183], v[12:13], v[12:13] op_sel_hi:[1,0,0]
    v_rcp_f32 v176, v176
    v_rcp_f32 v177, v177
    v_rcp_f32 v178, v178
    v_rcp_f32 v179, v179
    v_rcp_f32 v180, v180
    v_rcp_f32 v181, v181
    v_rcp_f32 v182, v182
    v_rcp_f32 v183, v183
    v_pk_mul_f32 v[176:177], v[176:177], v[112:113]
    v_pk_mul_f32 v[178:179], v[178:179], v[114:115]
    v_pk_mul_f32 v[180:181], v[180:181], v[116:117]
    v_pk_mul_f32 v[182:183], v[182:183], v[118:119]
    v_cvt_pk_bf16_f32 v200, v176, v177
    v_cvt_pk_bf16_f32 v201, v178, v179
    v_cvt_pk_bf16_f32 v202, v180, v181
    v_cvt_pk_bf16_f32 v203, v182, v183
    s_cmp_eq_u32 s12, 28
    s_cbranch_scc1 L_rare_19
L_back_20:
    buffer_store_dwordx4 v[200:203], v1, s[64:67], s84 offen offset:0 sc1
    v_subrev_u32 v94, 32768, v94
    v_subrev_u32 v95, 32768, v95
    ds_read_b64_tr_b16 v[240:241], v94 offset:0
    ds_read_b64_tr_b16 v[242:243], v94 offset:1024
    ds_read_b64_tr_b16 v[244:245], v95 offset:0
    ds_read_b64_tr_b16 v[246:247], v95 offset:1024
    v_pk_mul_f32 v[184:185], v[120:121], v[120:121]
    v_pk_mul_f32 v[186:187], v[122:123], v[122:123]
    v_pk_mul_f32 v[188:189], v[124:125], v[124:125]
    v_pk_mul_f32 v[190:191], v[126:127], v[126:127]
    v_pk_fma_f32 v[184:185], v[184:185], v[10:11], v[10:11] op_sel:[0,1,0] op_sel_hi:[1,1,0]
    v_pk_fma_f32 v[186:187], v[186:187], v[10:11], v[10:11] op_sel:[0,1,0] op_sel_hi:[1,1,0]
    v_pk_fma_f32 v[188:189], v[188:189], v[10:11], v[10:11] op_sel:[0,1,0] op_sel_hi:[1,1,0]
    v_pk_fma_f32 v[190:191], v[190:191], v[10:11], v[10:11] op_sel:[0,1,0] op_sel_hi:[1,1,0]
    v_pk_mul_f32 v[184:185], v[184:185], v[120:121]
    v_pk_mul_f32 v[186:187], v[186:187], v[122:123]
    v_pk_mul_f32 v[188:189], v[188:189], v[124:125]
    v_pk_mul_f32 v[190:191], v[190:191], v[126:127]
    s_add_u32 m0, s9, 24576
    s_nop 0
    buffer_load_dwordx4 v2, s[56:59], s92 offen lds
    s_add_u32 s92, s92, 65536
    s_cmp_eq_u32 s92, 1441792
    s_cselect_b32 s92, 0, s92
    v_exp_f32 v184, v184
    v_exp_f32 v185, v185
    v_exp_f32 v186, v186
    v_exp_f32 v187, v187
    v_exp_f32 v188, v188
    v_exp_f32 v189, v189
    v_exp_f32 v190, v190
    v_exp_f32 v191, v191
    s_add_u32 m0, s9, 32768
    s_nop 0
    buffer_load_dwordx4 v2, s[56:59], s92 offen lds
    s_add_u32 s92, s92, 65536
    s_cmp_eq_u32 s92, 1441792
    s_cselect_b32 s92, 0, s92
    v_pk_fma_f32 v[184:185], v[184:185], v[12:13], v[12:13] op_sel_hi:[1,0,0]
    v_pk_fma_f32 v[186:187], v[186:187], v[12:13], v[12:13] op_sel_hi:[1,0,0]
    v_pk_fma_f32 v[188:189], v[188:189], v[12:13], v[12:13] op_sel_hi:[1,0,0]
    v_pk_fma_f32 v[190:191], v[190:191], v[12:13], v[12:13] op_sel_hi:[1,0,0]
    v_rcp_f32 v184, v184
    v_rcp_f32 v185, v185
    v_rcp_f32 v186, v186
    v_rcp_f32 v187, v187
    v_rcp_f32 v188, v188
    v_rcp_f32 v189, v189
    v_rcp_f32 v190, v190
    v_rcp_f32 v191, v191
    v_pk_mul_f32 v[184:185], v[184:185], v[120:121]
    v_pk_mul_f32 v[186:187], v[186:187], v[122:123]
    v_pk_mul_f32 v[188:189], v[188:189], v[124:125]
    v_pk_mul_f32 v[190:191], v[190:191], v[126:127]
    v_cvt_pk_bf16_f32 v204, v184, v185
    v_cvt_pk_bf16_f32 v205, v186, v187
    v_cvt_pk_bf16_f32 v206, v188, v189
    v_cvt_pk_bf16_f32 v207, v190, v191
    s_cmp_eq_u32 s12, 28
    s_cbranch_scc1 L_rare_21
L_back_22:
    buffer_store_dwordx4 v[204:207], v1, s[64:67], s84 offen offset:1024 sc1
    ds_read_b64_tr_b16 v[232:233], v94 offset:8192
    ds_read_b64_tr_b16 v[234:235], v94 offset:9216
    ds_read_b64_tr_b16 v[236:237], v95 offset:8192
    ds_read_b64_tr_b16 v[238:239], v95 offset:9216
    v_pk_mul_f32 v[192:193], v[104:105], v[104:105]
    v_pk_mul_f32 v[194:195], v[106:107], v[106:107]
    v_pk_mul_f32 v[196:197], v[108:109], v[108:109]
    v_pk_mul_f32 v[198:199], v[110:111], v[110:111]
    v_pk_fma_f32 v[192:193], v[192:193], v[10:11], v[10:11] op_sel:[0,1,0] op_sel_hi:[1,1,0]
    v_pk_fma_f32 v[194:195], v[194:195], v[10:11], v[10:11] op_sel:[0,1,0] op_sel_hi:[1,1,0]
    v_pk_fma_f32 v[196:197], v[196:197], v[10:11], v[10:11] op_sel:[0,1,0] op_sel_hi:[1,1,0]
    v_pk_fma_f32 v[198:199], v[198:199], v[10:11], v[10:11] op_sel:[0,1,0] op_sel_hi:[1,1,0]
    v_pk_mul_f32 v[192:193], v[192:193], v[104:105]
    v_pk_mul_f32 v[194:195], v[194:195], v[106:107]
    v_pk_mul_f32 v[196:197], v[196:197], v[108:109]
    v_pk_mul_f32 v[198:199], v[198:199], v[110:111]
    v_exp_f32 v192, v192
    v_exp_f32 v193, v193
    v_exp_f32 v194, v194
    v_exp_f32 v195, v195
    v_exp_f32 v196, v196
    v_exp_f32 v197, v197
    v_exp_f32 v198, v198
    v_exp_f32 v199, v199
    v_pk_fma_f32 v[192:193], v[192:193], v[12:13], v[12:13] op_sel_hi:[1,0,0]
    v_pk_fma_f32 v[194:195], v[194:195], v[12:13], v[12:13] op_sel_hi:[1,0,0]
    v_pk_fma_f32 v[196:197], v[196:197], v[12:13], v[12:13] op_sel_hi:[1,0,0]
    v_pk_fma_f32 v[198:199], v[198:199], v[12:13], v[12:13] op_sel_hi:[1,0,0]
    v_rcp_f32 v192, v192
    v_rcp_f32 v193, v193
    v_rcp_f32 v194, v194
    v_rcp_f32 v195, v195
    v_rcp_f32 v196, v196
    v_rcp_f32 v197, v197
    v_rcp_f32 v198, v198
    v_rcp_f32 v199, v199
    v_pk_mul_f32 v[192:193], v[192:193], v[104:105]
    v_pk_mul_f32 v[194:195], v[194:195], v[106:107]
    v_pk_mul_f32 v[196:197], v[196:197], v[108:109]
    v_pk_mul_f32 v[198:199], v[198:199], v[110:111]
    v_cvt_pk_bf16_f32 v208, v192, v193
    v_cvt_pk_bf16_f32 v209, v194, v195
    v_cvt_pk_bf16_f32 v210, v196, v197
    v_cvt_pk_bf16_f32 v211, v198, v199
    buffer_store_dwordx4 v[208:211], v1, s[64:67], s85 offen sc1
    s_mov_b32 s0, 0x3eb8aa3b
    s_mov_b32 s1, 0x3eb8aa3b
    v_pk_mul_f32 v[96:97], v[96:97], s[0:1]
    v_pk_mul_f32 v[98:99], v[98:99], s[0:1]
    v_pk_mul_f32 v[100:101], v[100:101], s[0:1]
    v_pk_mul_f32 v[102:103], v[102:103], s[0:1]
    v_cvt_pk_bf16_f32 v156, v96, v97
    v_cvt_pk_bf16_f32 v157, v98, v99
    v_cvt_pk_bf16_f32 v158, v100, v101
    v_cvt_pk_bf16_f32 v159, v102, v103
    v_lshrrev_b32 v20, 2, v1
    v_and_b32 v20, 0x7c, v20
    v_add_u32 v20, s95, v20
    ds_read_b32 v20, v20
    s_waitcnt lgkmcnt(0)
    s_waitcnt vmcnt(2)
    s_barrier
    s_setprio 3
    ds_read_b128 v[144:147], v8 offset:8192
    ds_read_b128 v[148:151], v8 offset:0
    ds_read_b128 v[152:155], v8 offset:7168
    v_mov_b64 v[16:17], 0
    s_waitcnt lgkmcnt(2)
    v_dot2c_f32_bf16 v16, v144, v156
    v_dot2c_f32_bf16 v17, v145, v157
    v_dot2c_f32_bf16 v16, v146, v158
    v_dot2c_f32_bf16 v17, v147, v159
    s_nop 2
    v_add_f32 v16, v16, v17
    v_mov_b32 v17, v16
    s_nop 1
    v_permlane32_swap_b32 v16, v17
    v_add_f32 v16, v16, v17
    v_sub_f32 v16, 0, v16
    v_mov_b32 v17, v16
    v_add_u32 v3, s87, v1
    s_mov_b32 s75, 0
    s_mov_b32 s90, s93
    v_mov_b64 v[96:97], v[16:17]
    v_mov_b64 v[98:99], v[16:17]
    v_mov_b64 v[100:101], v[16:17]
    v_mov_b64 v[102:103], v[16:17]
    v_mov_b64 v[104:105], v[16:17]
    v_mov_b64 v[106:107], v[16:17]
    v_mov_b64 v[108:109], v[16:17]
    v_mov_b64 v[110:111], v[16:17]
    s_mov_b64 exec, s[96:97]
    ds_read_b128 v[76:79], v9 offset:16384
    ds_read_b128 v[80:83], v9 offset:17408
    s_mov_b64 exec, -1
    s_mov_b64 exec, s[96:97]
    ds_read_b128 v[84:87], v9 offset:0
    ds_read_b128 v[88:91], v9 offset:1024
    s_mov_b64 exec, -1
    s_waitcnt lgkmcnt(6)
    v_mfma_f32_32x32x16_bf16 v[32:47], v[144:147], v[156:159], v[96:111]
    ds_read_b128 v[144:147], v8 offset:6144
    s_waitcnt lgkmcnt(6)
    v_mfma_f32_32x32x16_bf16 v[128:143], v[148:151], v[156:159], v[96:111]
    ds_read_b128 v[148:151], v8 offset:5120
    s_waitcnt lgkmcnt(6)
    s_cmp_eq_u32 s88, 8
    s_cbranch_scc1 L_rare_23
L_back_24:
    v_mfma_f32_32x32x16_bf16 v[48:63], v[152:155], v[156:159], v[96:111]
    ds_read_b128 v[152:155], v8 offset:4096
    s_cmp_gt_u32 s88, 0
    s_cbranch_scc1 L_rare_25
L_back_26:
    s_nop 3
    v_cndmask_b32 v32, v128, v32, s[16:17]
    v_cndmask_b32 v33, v129, v33, s[18:19]
    v_cndmask_b32 v34, v130, v34, s[20:21]
    v_cndmask_b32 v35, v131, v35, s[22:23]
    v_cndmask_b32 v36, v132, v36, s[24:25]
    v_cndmask_b32 v37, v133, v37, s[26:27]
    v_cndmask_b32 v38, v134, v38, s[28:29]
    v_cndmask_b32 v39, v135, v39, s[30:31]
    v_cndmask_b32 v40, v136, v40, s[32:33]
    v_cndmask_b32 v41, v137, v41, s[34:35]
    v_cndmask_b32 v42, v138, v42, s[36:37]
    v_cndmask_b32 v43, v139, v43, s[38:39]
    v_cndmask_b32 v44, v140, v44, s[40:41]
    v_cndmask_b32 v45, v141, v45, s[42:43]
    v_cndmask_b32 v46, v142, v46, s[44:45]
    v_cndmask_b32 v47, v143, v47, s[46:47]
    v_exp_f32 v32, v32
    v_exp_f32 v33, v33
    s_add_u32 m0, s9, 40960
    s_nop 0
    buffer_load_dwordx4 v2, s[56:59], s92 offen lds
    s_add_u32 s92, s92, 65536
    s_cmp_eq_u32 s92, 1441792
    s_cselect_b32 s92, 0, s92
    v_exp_f32 v34, v34
    v_exp_f32 v35, v35
    ds_read_b64_tr_b16 v[224:225], v94 offset:16384
    ds_read_b64_tr_b16 v[226:227], v94 offset:17408
    ds_read_b64_tr_b16 v[228:229], v95 offset:16384
    ds_read_b64_tr_b16 v[230:231], v95 offset:17408
    v_exp_f32 v36, v36
    v_exp_f32 v37, v37
    s_add_u32 m0, s9, 49152
    s_nop 0
    buffer_load_dwordx4 v2, s[56:59], s92 offen lds
    s_add_u32 s92, s92, 65536
    s_cmp_eq_u32 s92, 1441792
    s_cselect_b32 s92, 0, s92
    v_exp_f32 v38, v38
    v_exp_f32 v39, v39
    ds_read_b64_tr_b16 v[216:217], v94 offset:24576
    ds_read_b64_tr_b16 v[218:219], v94 offset:25600
    ds_read_b64_tr_b16 v[220:221], v95 offset:24576
    ds_read_b64_tr_b16 v[222:223], v95 offset:25600
    v_exp_f32 v40, v40
    v_exp_f32 v41, v41
    s_add_u32 m0, s9, 57344
    s_nop 0
    buffer_load_dwordx4 v2, s[56:59], s92 offen lds
    s_add_u32 s92, s92, 65536
    s_cmp_eq_u32 s92, 1441792
    s_cselect_b32 s92, 0, s92
    v_exp_f32 v42, v42
    v_exp_f32 v43, v43
    v_subrev_u32 v94, 65536, v94
    v_subrev_u32 v95, 65536, v95
    ds_read_b64_tr_b16 v[208:209], v94 offset:0
    ds_read_b64_tr_b16 v[210:211], v94 offset:1024
    ds_read_b64_tr_b16 v[212:213], v95 offset:0
    ds_read_b64_tr_b16 v[214:215], v95 offset:1024
    v_exp_f32 v44, v44
    v_exp_f32 v45, v45
    s_add_u32 m0, s9, 147456
    s_nop 0
    buffer_load_dwordx4 v2, s[56:59], s92 offen lds
    s_add_u32 s92, s92, 65536
    s_cmp_eq_u32 s92, 1441792
    s_cselect_b32 s92, 0, s92
    v_exp_f32 v46, v46
    v_exp_f32 v47, v47
    ds_read_b64_tr_b16 v[200:201], v94 offset:8192
    ds_read_b64_tr_b16 v[202:203], v94 offset:9216
    ds_read_b64_tr_b16 v[204:205], v95 offset:8192
    ds_read_b64_tr_b16 v[206:207], v95 offset:9216
    s_waitcnt vmcnt(4)
    v_mov_b64 v[28:29], s[100:101]
    s_mov_b64 exec, 1
    buffer_store_dwordx2 v[28:29], off, s[64:67], s83 sc1
    s_mov_b64 exec, -1
    v_cvt_pk_bf16_f32 v64, v32, v33
    v_cvt_pk_bf16_f32 v65, v34, v35
    v_cvt_pk_bf16_f32 v66, v36, v37
    v_cvt_pk_bf16_f32 v67, v38, v39
    v_cvt_pk_bf16_f32 v68, v40, v41
    v_cvt_pk_bf16_f32 v69, v42, v43
    v_cvt_pk_bf16_f32 v70, v44, v45
    v_cvt_pk_bf16_f32 v71, v46, v47
    v_bfi_b32 v128, v160, 0, v64
    v_and_b32 v64, v160, v64
    v_bfi_b32 v129, v161, 0, v65
    v_and_b32 v65, v161, v65
    v_bfi_b32 v130, v162, 0, v66
    v_and_b32 v66, v162, v66
    v_bfi_b32 v131, v163, 0, v67
    v_and_b32 v67, v163, v67
    v_bfi_b32 v132, v164, 0, v68
    v_and_b32 v68, v164, v68
    v_bfi_b32 v133, v165, 0, v69
    v_and_b32 v69, v165, v69
    v_bfi_b32 v134, v166, 0, v70
    v_and_b32 v70, v166, v70
    v_bfi_b32 v135, v167, 0, v71
    v_and_b32 v71, v167, v71
    v_exp_f32 v48, v48
    s_waitcnt lgkmcnt(15)
    s_cmp_eq_u32 s88, 7
    s_cbranch_scc1 L_rare_27
L_back_28:
    v_mfma_f32_32x32x16_bf16 v[32:47], v[144:147], v[156:159], v[96:111]
    ds_read_b128 v[144:147], v8 offset:3072
    v_exp_f32 v49, v49
    s_add_u32 m0, s9, 65536
    s_nop 0
    buffer_load_dwordx4 v2, s[56:59], s92 offen lds
    s_add_u32 s92, s92, 65536
    s_cmp_eq_u32 s92, 1441792
    s_cselect_b32 s92, 0, s92
    v_exp_f32 v50, v50
    s_lshr_b32 s3, s2, 3
    s_lshl_b32 s3, s3, 14
    s_add_u32 s3, s3, s10
    v_and_b32 v30, 15, v0
    v_lshlrev_b32 v30, 7, v30
    buffer_load_dword v31, v30, s[60:63], s3 offen
    v_exp_f32 v51, v51
    s_waitcnt lgkmcnt(15)
    v_mfma_f32_32x32x16_bf16 v[112:127], v[76:79], v[64:67], 0
    ds_read_b64_tr_b16 v[192:193], v94 offset:16384
    ds_read_b64_tr_b16 v[194:195], v94 offset:17408
    ds_read_b64_tr_b16 v[196:197], v95 offset:16384
    ds_read_b64_tr_b16 v[198:199], v95 offset:17408
    v_exp_f32 v52, v52
    v_exp_f32 v53, v53
    s_add_u32 m0, s9, 73728
    s_nop 0
    buffer_load_dwordx4 v2, s[56:59], s92 offen lds
    s_add_u32 s92, s92, 65536
    s_cmp_eq_u32 s92, 1441792
    s_cselect_b32 s92, 0, s92
    v_exp_f32 v54, v54
    v_exp_f32 v55, v55
    v_mfma_f32_32x32x16_bf16 v[112:127], v[80:83], v[68:71], v[112:127]
    s_mov_b64 exec, s[96:97]
    ds_read_b128 v[76:79], v9 offset:14336
    ds_read_b128 v[80:83], v9 offset:15360
    s_mov_b64 exec, -1
    ds_read_b64_tr_b16 v[184:185], v94 offset:24576
    ds_read_b64_tr_b16 v[186:187], v94 offset:25600
    ds_read_b64_tr_b16 v[188:189], v95 offset:24576
    ds_read_b64_tr_b16 v[190:191], v95 offset:25600
    v_exp_f32 v56, v56
    v_exp_f32 v57, v57
    s_add_u32 m0, s9, 155648
    s_nop 0
    buffer_load_dwordx4 v2, s[56:59], s92 offen lds
    s_add_u32 s92, s92, 65536
    s_cmp_eq_u32 s92, 1441792
    s_cselect_b32 s92, 0, s92
    v_exp_f32 v58, v58
    v_exp_f32 v59, v59
    v_mfma_f32_32x32x16_bf16 v[112:127], v[84:87], v[128:131], v[112:127]
    ds_read_b64_tr_b16 v[176:177], v94 offset:32768
    ds_read_b64_tr_b16 v[178:179], v94 offset:33792
    ds_read_b64_tr_b16 v[180:181], v95 offset:32768
    ds_read_b64_tr_b16 v[182:183], v95 offset:33792
    v_exp_f32 v60, v60
    v_exp_f32 v61, v61
    v_exp_f32 v62, v62
    v_exp_f32 v63, v63
    v_mfma_f32_32x32x16_bf16 v[112:127], v[88:91], v[132:135], v[112:127]
    s_mov_b64 exec, s[96:97]
    ds_read_b128 v[84:87], v9 offset:12288
    ds_read_b128 v[88:91], v9 offset:13312
    s_mov_b64 exec, -1
    s_waitcnt lgkmcnt(0)
    s_barrier
    v_cvt_pk_bf16_f32 v64, v48, v49
    v_cvt_pk_bf16_f32 v65, v50, v51
    v_cvt_pk_bf16_f32 v66, v52, v53
    v_cvt_pk_bf16_f32 v67, v54, v55
    v_cvt_pk_bf16_f32 v68, v56, v57
    v_cvt_pk_bf16_f32 v69, v58, v59
    v_cvt_pk_bf16_f32 v70, v60, v61
    v_cvt_pk_bf16_f32 v71, v62, v63
    v_exp_f32 v32, v32
    s_setprio 2
    v_exp_f32 v33, v33
    s_waitcnt lgkmcnt(15)
    s_cmp_eq_u32 s88, 6
    s_cbranch_scc1 L_rare_29
L_back_30:
    v_mfma_f32_32x32x16_bf16 v[48:63], v[148:151], v[156:159], v[96:111]
    ds_read_b128 v[148:151], v8 offset:2048
    s_add_u32 m0, s9, 0
    s_nop 0
    buffer_load_dwordx4 v2, s[56:59], s92 offen lds
    s_add_u32 s92, s92, 65536
    s_cmp_eq_u32 s92, 1441792
    s_cselect_b32 s92, 0, s92
    v_exp_f32 v34, v34
    v_exp_f32 v35, v35
    v_exp_f32 v36, v36
    v_exp_f32 v37, v37
    s_add_u32 m0, s9, 8192
    s_nop 0
    buffer_load_dwordx4 v2, s[56:59], s92 offen lds
    s_add_u32 s92, s92, 65536
    s_cmp_eq_u32 s92, 1441792
    s_cselect_b32 s92, 0, s92
    v_exp_f32 v38, v38
    s_waitcnt lgkmcnt(11)
    v_mfma_f32_32x32x16_bf16 v[112:127], v[76:79], v[64:67], v[112:127]
    v_exp_f32 v39, v39
    v_exp_f32 v40, v40
    v_exp_f32 v41, v41
    s_add_u32 m0, s9, 16384
    s_nop 0
    buffer_load_dwordx4 v2, s[56:59], s92 offen lds
    s_add_u32 s92, s92, 65536
    s_cmp_eq_u32 s92, 1441792
    s_cselect_b32 s92, 0, s92
    v_exp_f32 v42, v42
    v_exp_f32 v43, v43
    v_mfma_f32_32x32x16_bf16 v[112:127], v[80:83], v[68:71], v[112:127]
    s_mov_b64 exec, s[96:97]
    ds_read_b128 v[76:79], v9 offset:10240
    ds_read_b128 v[80:83], v9 offset:11264
    s_mov_b64 exec, -1
    v_exp_f32 v44, v44
    v_exp_f32 v45, v45
    s_add_u32 m0, s9, 24576
    s_nop 0
    buffer_load_dwordx4 v2, s[56:59], s92 offen lds
    s_add_u32 s92, s92, 65536
    s_cmp_eq_u32 s92, 1441792
    s_cselect_b32 s92, 0, s92
    v_exp_f32 v46, v46
    v_exp_f32 v47, v47
    v_cvt_pk_bf16_f32 v64, v32, v33
    v_cvt_pk_bf16_f32 v65, v34, v35
    v_cvt_pk_bf16_f32 v66, v36, v37
    v_cvt_pk_bf16_f32 v67, v38, v39
    v_cvt_pk_bf16_f32 v68, v40, v41
    v_cvt_pk_bf16_f32 v69, v42, v43
    v_cvt_pk_bf16_f32 v70, v44, v45
    v_cvt_pk_bf16_f32 v71, v46, v47
    v_exp_f32 v48, v48
    v_exp_f32 v49, v49
    s_waitcnt lgkmcnt(15)
    s_cmp_eq_u32 s88, 5
    s_cbranch_scc1 L_rare_31
L_back_32:
    v_mfma_f32_32x32x16_bf16 v[32:47], v[152:155], v[156:159], v[96:111]
    ds_read_b128 v[152:155], v8 offset:1024
    s_add_u32 m0, s9, 32768
    s_nop 0
    buffer_load_dwordx4 v2, s[56:59], s92 offen lds
    s_add_u32 s92, s92, 65536
    v_exp_f32 v50, v50
    v_exp_f32 v51, v51
    v_exp_f32 v52, v52
    v_exp_f32 v53, v53
    s_add_u32 m0, s9, 81920
    s_lshl_b32 s92, s94, 16
    buffer_load_dwordx4 v2, s[60:63], s92 offen lds
    s_add_u32 s92, s92, 65536
    s_bitset0_b32 s92, 19
    v_exp_f32 v54, v54
    s_waitcnt lgkmcnt(4)
    v_mfma_f32_32x32x16_bf16 v[112:127], v[84:87], v[64:67], v[112:127]
    v_exp_f32 v55, v55
    v_exp_f32 v56, v56
    v_exp_f32 v57, v57
    s_add_u32 m0, s9, 90112
    s_nop 0
    buffer_load_dwordx4 v2, s[60:63], s92 offen lds
    s_add_u32 s92, s92, 65536
    s_bitset0_b32 s92, 19
    v_exp_f32 v58, v58
    v_exp_f32 v59, v59
    v_mfma_f32_32x32x16_bf16 v[112:127], v[88:91], v[68:71], v[112:127]
    s_mov_b64 exec, s[96:97]
    ds_read_b128 v[84:87], v9 offset:8192
    ds_read_b128 v[88:91], v9 offset:9216
    s_mov_b64 exec, -1
    v_exp_f32 v60, v60
    v_exp_f32 v61, v61
    v_exp_f32 v62, v62
    v_exp_f32 v63, v63
    v_cvt_pk_bf16_f32 v64, v48, v49
    v_cvt_pk_bf16_f32 v65, v50, v51
    v_cvt_pk_bf16_f32 v66, v52, v53
    v_cvt_pk_bf16_f32 v67, v54, v55
    v_cvt_pk_bf16_f32 v68, v56, v57
    v_cvt_pk_bf16_f32 v69, v58, v59
    v_cvt_pk_bf16_f32 v70, v60, v61
    v_cvt_pk_bf16_f32 v71, v62, v63
    v_exp_f32 v32, v32
    s_setprio 1
    v_exp_f32 v33, v33
    s_waitcnt lgkmcnt(15)
    s_cmp_eq_u32 s88, 4
    s_cbranch_scc1 L_rare_33
L_back_34:
    v_mfma_f32_32x32x16_bf16 v[48:63], v[144:147], v[156:159], v[96:111]
    v_exp_f32 v34, v34
    v_exp_f32 v35, v35
    v_exp_f32 v36, v36
    v_exp_f32 v37, v37
    v_exp_f32 v38, v38
    s_waitcnt lgkmcnt(3)
    v_mfma_f32_32x32x16_bf16 v[112:127], v[76:79], v[64:67], v[112:127]
    v_exp_f32 v39, v39
    v_exp_f32 v40, v40
    v_mov_b64 v[18:19], 0
    buffer_load_dwordx2 v[18:19], v92, s[64:67], 0 offen sc1
    v_exp_f32 v41, v41
    v_exp_f32 v42, v42
    v_exp_f32 v43, v43
    v_mfma_f32_32x32x16_bf16 v[112:127], v[80:83], v[68:71], v[112:127]
    s_mov_b64 exec, s[96:97]
    ds_read_b128 v[76:79], v9 offset:6144
    ds_read_b128 v[80:83], v9 offset:7168
    s_mov_b64 exec, -1
    v_exp_f32 v44, v44
    v_exp_f32 v45, v45
    v_exp_f32 v46, v46
    v_exp_f32 v47, v47
    v_cvt_pk_bf16_f32 v64, v32, v33
    v_cvt_pk_bf16_f32 v65, v34, v35
    v_cvt_pk_bf16_f32 v66, v36, v37
    v_cvt_pk_bf16_f32 v67, v38, v39
    v_cvt_pk_bf16_f32 v68, v40, v41
    v_cvt_pk_bf16_f32 v69, v42, v43
    v_cvt_pk_bf16_f32 v70, v44, v45
    v_cvt_pk_bf16_f32 v71, v46, v47
    v_exp_f32 v48, v48
    v_exp_f32 v49, v49
    s_waitcnt lgkmcnt(7)
    s_cmp_eq_u32 s88, 3
    s_cbranch_scc1 L_rare_35
L_back_36:
    v_mfma_f32_32x32x16_bf16 v[32:47], v[148:151], v[156:159], v[96:111]
    v_exp_f32 v50, v50
    v_exp_f32 v51, v51
    v_exp_f32 v52, v52
    v_exp_f32 v53, v53
    v_exp_f32 v54, v54
    s_waitcnt lgkmcnt(2)
    v_mfma_f32_32x32x16_bf16 v[112:127], v[84:87], v[64:67], v[112:127]
    v_exp_f32 v55, v55
    v_exp_f32 v56, v56
    s_cmp_lt_u32 s75, 2
    s_cbranch_scc1 L_rare_37
L_back_38:
    v_exp_f32 v57, v57
    v_exp_f32 v58, v58
    v_exp_f32 v59, v59
    v_mfma_f32_32x32x16_bf16 v[112:127], v[88:91], v[68:71], v[112:127]
    s_mov_b64 exec, s[96:97]
    ds_read_b128 v[84:87], v9 offset:4096
    ds_read_b128 v[88:91], v9 offset:5120
    s_mov_b64 exec, -1
    v_exp_f32 v60, v60
    v_exp_f32 v61, v61
    v_exp_f32 v62, v62
    v_exp_f32 v63, v63
    v_cvt_pk_bf16_f32 v64, v48, v49
    v_cvt_pk_bf16_f32 v65, v50, v51
    v_cvt_pk_bf16_f32 v66, v52, v53
    v_cvt_pk_bf16_f32 v67, v54, v55
    v_cvt_pk_bf16_f32 v68, v56, v57
    v_cvt_pk_bf16_f32 v69, v58, v59
    v_cvt_pk_bf16_f32 v70, v60, v61
    v_cvt_pk_bf16_f32 v71, v62, v63
    v_exp_f32 v32, v32
    s_setprio 0
    v_exp_f32 v33, v33
    s_waitcnt lgkmcnt(6)
    s_cmp_eq_u32 s88, 2
    s_cbranch_scc1 L_rare_39
L_back_40:
    v_mfma_f32_32x32x16_bf16 v[48:63], v[152:155], v[156:159], v[96:111]
    v_exp_f32 v34, v34
    v_exp_f32 v35, v35
    v_exp_f32 v36, v36
    v_exp_f32 v37, v37
    v_exp_f32 v38, v38
    s_waitcnt lgkmcnt(2)
    v_mfma_f32_32x32x16_bf16 v[112:127], v[76:79], v[64:67], v[112:127]
    v_exp_f32 v39, v39
    v_exp_f32 v40, v40
    s_cmp_lt_u32 s75, 2
    s_cbranch_scc1 L_rare_41
L_back_42:
    v_exp_f32 v41, v41
    v_exp_f32 v42, v42
    v_exp_f32 v43, v43
    v_mfma_f32_32x32x16_bf16 v[112:127], v[80:83], v[68:71], v[112:127]
    s_mov_b64 exec, s[96:97]
    ds_read_b128 v[76:79], v9 offset:2048
    ds_read_b128 v[80:83], v9 offset:3072
    s_mov_b64 exec, -1
    v_exp_f32 v44, v44
    v_exp_f32 v45, v45
    v_exp_f32 v46, v46
    v_exp_f32 v47, v47
    v_cvt_pk_bf16_f32 v64, v32, v33
    v_cvt_pk_bf16_f32 v65, v34, v35
    v_cvt_pk_bf16_f32 v66, v36, v37
    v_cvt_pk_bf16_f32 v67, v38, v39
    v_cvt_pk_bf16_f32 v68, v40, v41
    v_cvt_pk_bf16_f32 v69, v42, v43
    v_cvt_pk_bf16_f32 v70, v44, v45
    v_cvt_pk_bf16_f32 v71, v46, v47
    v_exp_f32 v48, v48
    v_exp_f32 v49, v49
    v_exp_f32 v50, v50
    v_exp_f32 v51, v51
    v_exp_f32 v52, v52
    v_exp_f32 v53, v53
    v_exp_f32 v54, v54
    s_waitcnt lgkmcnt(2)
    v_mfma_f32_32x32x16_bf16 v[112:127], v[84:87], v[64:67], v[112:127]
    v_exp_f32 v55, v55
    v_exp_f32 v56, v56
    s_cmp_lt_u32 s75, 2
    s_cbranch_scc1 L_rare_43
L_back_44:
    v_exp_f32 v57, v57
    v_exp_f32 v58, v58
    v_exp_f32 v59, v59
    v_mfma_f32_32x32x16_bf16 v[112:127], v[88:91], v[68:71], v[112:127]
    v_exp_f32 v60, v60
    v_exp_f32 v61, v61
    v_exp_f32 v62, v62
    v_exp_f32 v63, v63
    v_cvt_pk_bf16_f32 v64, v48, v49
    v_cvt_pk_bf16_f32 v65, v50, v51
    v_cvt_pk_bf16_f32 v66, v52, v53
    v_cvt_pk_bf16_f32 v67, v54, v55
    v_cvt_pk_bf16_f32 v68, v56, v57
    v_cvt_pk_bf16_f32 v69, v58, v59
    v_cvt_pk_bf16_f32 v70, v60, v61
    v_cvt_pk_bf16_f32 v71, v62, v63
    s_waitcnt lgkmcnt(0)
    v_mfma_f32_32x32x16_bf16 v[112:127], v[76:79], v[64:67], v[112:127]
    v_mfma_f32_32x32x16_bf16 v[112:127], v[80:83], v[68:71], v[112:127]
    s_mov_b32 s3, 0x4e800000
    s_nop 10
    v_cmp_nle_f32 vcc, v120, s3
    s_nop 0
    s_cbranch_vccnz L_rare_45
L_back_46:
    v_rcp_f32 v28, v120
    s_nop 0
    v_mul_f32 v28, v28, v13
    v_pk_mul_f32 v[112:113], v[112:113], v[28:29] op_sel_hi:[1,0]
    v_pk_mul_f32 v[114:115], v[114:115], v[28:29] op_sel_hi:[1,0]
    v_pk_mul_f32 v[116:117], v[116:117], v[28:29] op_sel_hi:[1,0]
    v_pk_mul_f32 v[118:119], v[118:119], v[28:29] op_sel_hi:[1,0]
    v_cvt_pk_bf16_f32 v64, v112, v113
    v_cvt_pk_bf16_f32 v65, v114, v115
    v_cvt_pk_bf16_f32 v66, v116, v117
    v_cvt_pk_bf16_f32 v67, v118, v119
    s_add_u32 s83, s83, 32
    s_cmp_lt_u32 s75, 2
    s_cbranch_scc1 L_rare_47
L_back_48:
    buffer_store_dwordx4 v[64:67], v1, s[64:67], s86 offen sc1
    v_and_b32 v96, 0xffff, v6
    v_lshl_or_b32 v96, v96, 16, v96
    v_mov_b32 v97, 0
    v_mov_b64 v[98:99], 0
    v_lshrrev_b32 v100, 16, v6
    v_lshl_or_b32 v100, v100, 16, v100
    v_mov_b32 v101, 0
    v_mov_b64 v[102:103], 0
    v_mov_b32 v105, 0
    v_mov_b64 v[106:107], 0
    v_cvt_pk_bf16_f32 v28, v20, v20
    v_and_b32 v28, 0xffff0000, v28
    v_sub_f32 v29, v20, v28
    v_cvt_pk_bf16_f32 v104, v28, v29
    s_nop 1
    v_mfma_f32_32x32x16_bf16 v[32:47], v[96:99], v[104:107], 0
    v_mfma_f32_32x32x16_bf16 v[48:63], v[100:103], v[104:107], 0
    s_setprio 3
    s_waitcnt vmcnt(1)
    v_mfma_f32_32x32x16_bf16 v[32:47], v[248:251], v[168:171], v[32:47]
    v_mfma_f32_32x32x16_bf16 v[48:63], v[252:255], v[168:171], v[48:63]
    buffer_load_dwordx4 v[132:135], v3, s[64:67], s93 offen sc1
    s_add_u32 s93, s93, 4096
    s_cmp_eq_u32 s93, 90112
    s_cselect_b32 s93, 0, s93
    v_and_b32 v30, 31, v0
    v_lshlrev_b32 v31, 8, v30
    s_lshl_b32 s3, s4, 13
    s_add_u32 s3, s3, 0
    v_add_u32 v153, s3, v31
    v_and_b32 v30, 7, v0
    v_lshrrev_b32 v31, 5, v0
    v_xor_b32 v30, v30, v31
    v_lshl_add_u32 v152, v30, 4, v153
    v_xor_b32 v153, 32, v152
    v_xor_b32 v154, 64, v152
    v_xor_b32 v155, 96, v152
    s_waitcnt vmcnt(2)
    v_mfma_f32_32x32x16_bf16 v[32:47], v[240:243], v[172:175], v[32:47]
    v_mfma_f32_32x32x16_bf16 v[48:63], v[244:247], v[172:175], v[48:63]
    buffer_load_dwordx4 v[136:139], v3, s[64:67], s93 offen sc1
    s_add_u32 s93, s93, 4096
    s_cmp_eq_u32 s93, 90112
    s_cselect_b32 s93, 0, s93
    s_waitcnt vmcnt(3)
    v_mfma_f32_32x32x16_bf16 v[32:47], v[232:235], v[72:75], v[32:47]
    v_mfma_f32_32x32x16_bf16 v[48:63], v[236:239], v[72:75], v[48:63]
    s_waitcnt vmcnt(2)
    v_mov_b64 v[22:23], s[100:101]
    s_mov_b64 exec, 1
    buffer_store_dwordx2 v[22:23], off, s[64:67], s83 sc1
    s_mov_b64 exec, -1
    buffer_load_dwordx4 v[140:143], v3, s[64:67], s93 offen sc1
    s_add_u32 s93, s93, 4096
    s_cmp_eq_u32 s93, 90112
    s_cselect_b32 s93, 0, s93
    s_waitcnt vmcnt(5)
    v_mfma_f32_32x32x16_bf16 v[32:47], v[224:227], v[160:163], v[32:47]
    v_mfma_f32_32x32x16_bf16 v[48:63], v[228:231], v[160:163], v[48:63]
    buffer_load_dwordx4 v[24:27], v3, s[64:67], s93 offen sc1
    s_add_u32 s93, s93, 4096
    s_cmp_eq_u32 s93, 90112
    s_cselect_b32 s93, 0, s93
    s_waitcnt vmcnt(6)
    v_mfma_f32_32x32x16_bf16 v[32:47], v[216:219], v[164:167], v[32:47]
    v_mfma_f32_32x32x16_bf16 v[48:63], v[220:223], v[164:167], v[48:63]
    buffer_load_dwordx4 v[76:79], v3, s[64:67], s93 offen sc1
    s_add_u32 s93, s93, 4096
    s_cmp_eq_u32 s93, 90112
    s_cselect_b32 s93, 0, s93
    v_lshrrev_b32 v28, 3, v0
    v_and_b32 v29, 7, v0
    v_lshlrev_b32 v29, 1, v29
    v_xor_b32 v29, v29, v28
    s_lshl_b32 s3, s5, 11
    s_lshl_b32 s0, s6, 13
    s_add_u32 s3, s3, s0
    s_add_u32 s3, s3, 0
    v_lshlrev_b32 v30, 8, v28
    v_lshl_add_u32 v30, v29, 4, v30
    v_add_u32 v30, s3, v30
    v_xor_b32 v31, 16, v30
    v_lshlrev_b32 v28, 10, v28
    v_and_b32 v29, 0x70, v1
    v_add_u32 v28, v28, v29
    s_waitcnt vmcnt(7)
    v_mfma_f32_32x32x16_bf16 v[32:47], v[208:211], v[128:131], v[32:47]
    v_mfma_f32_32x32x16_bf16 v[48:63], v[212:215], v[128:131], v[48:63]
    s_setprio 2
    buffer_load_dwordx4 v[80:83], v3, s[64:67], s93 offen sc1
    s_add_u32 s93, s93, 4096
    s_cmp_eq_u32 s93, 90112
    s_cselect_b32 s93, 0, s93
    s_waitcnt vmcnt(6)
    v_mfma_f32_32x32x16_bf16 v[32:47], v[200:203], v[132:135], v[32:47]
    v_mfma_f32_32x32x16_bf16 v[48:63], v[204:207], v[132:135], v[48:63]
    s_waitcnt vmcnt(8)
    s_barrier
    ds_read_b64_tr_b16 v[112:113], v94 offset:40960
    ds_read_b64_tr_b16 v[114:115], v94 offset:41984
    ds_read_b64_tr_b16 v[116:117], v95 offset:40960
    ds_read_b64_tr_b16 v[118:119], v95 offset:41984
    buffer_load_dwordx4 v[84:87], v3, s[64:67], s93 offen sc1
    s_add_u32 s93, s93, 4096
    s_cmp_eq_u32 s93, 90112
    s_cselect_b32 s93, 0, s93
    s_add_u32 m0, s9, 98304
    s_nop 0
    buffer_load_dwordx4 v2, s[60:63], s92 offen lds
    s_add_u32 s92, s92, 65536
    s_bitset0_b32 s92, 19
    s_waitcnt vmcnt(7)
    v_mfma_f32_32x32x16_bf16 v[32:47], v[192:195], v[136:139], v[32:47]
    v_mfma_f32_32x32x16_bf16 v[48:63], v[196:199], v[136:139], v[48:63]
    ds_read_b64_tr_b16 v[120:121], v94 offset:49152
    ds_read_b64_tr_b16 v[122:123], v94 offset:50176
    ds_read_b64_tr_b16 v[124:125], v95 offset:49152
    ds_read_b64_tr_b16 v[126:127], v95 offset:50176
    buffer_load_dwordx4 v[88:91], v3, s[64:67], s93 offen sc1
    s_add_u32 s93, s93, 4096
    s_cmp_eq_u32 s93, 90112
    s_cselect_b32 s93, 0, s93
    s_add_u32 m0, s9, 106496
    s_nop 0
    buffer_load_dwordx4 v2, s[60:63], s92 offen lds
    s_add_u32 s92, s92, 65536
    s_bitset0_b32 s92, 19
    s_waitcnt vmcnt(7)
    v_mfma_f32_32x32x16_bf16 v[32:47], v[184:187], v[140:143], v[32:47]
    v_mfma_f32_32x32x16_bf16 v[48:63], v[188:191], v[140:143], v[48:63]
    ds_read_b64_tr_b16 v[96:97], v94 offset:57344
    ds_read_b64_tr_b16 v[98:99], v94 offset:58368
    ds_read_b64_tr_b16 v[100:101], v95 offset:57344
    ds_read_b64_tr_b16 v[102:103], v95 offset:58368
    buffer_load_dwordx4 v[144:147], v3, s[64:67], s93 offen sc1
    s_add_u32 s93, s93, 4096
    s_cmp_eq_u32 s93, 90112
    s_cselect_b32 s93, 0, s93
    s_add_u32 m0, s9, 114688
    s_nop 0
    buffer_load_dwordx4 v2, s[60:63], s92 offen lds
    s_add_u32 s92, s92, 65536
    s_bitset0_b32 s92, 19
    s_waitcnt vmcnt(8)
    v_mfma_f32_32x32x16_bf16 v[32:47], v[176:179], v[24:27], v[32:47]
    v_mfma_f32_32x32x16_bf16 v[48:63], v[180:183], v[24:27], v[48:63]
    v_add_u32 v94, 98304, v94
    v_add_u32 v95, 98304, v95
    ds_read_b64_tr_b16 v[104:105], v94 offset:49152
    ds_read_b64_tr_b16 v[106:107], v94 offset:50176
    ds_read_b64_tr_b16 v[108:109], v95 offset:49152
    ds_read_b64_tr_b16 v[110:111], v95 offset:50176
    buffer_load_dwordx4 v[148:151], v3, s[64:67], s93 offen sc1
    s_add_u32 s93, s93, 4096
    s_cmp_eq_u32 s93, 90112
    s_cselect_b32 s93, 0, s93
    s_add_u32 m0, s9, 122880
    s_nop 0
    buffer_load_dwordx4 v2, s[60:63], s92 offen lds
    s_add_u32 s92, s92, 65536
    s_bitset0_b32 s92, 19
    s_waitcnt vmcnt(9) lgkmcnt(12)
    v_mfma_f32_32x32x16_bf16 v[32:47], v[112:115], v[76:79], v[32:47]
    v_mfma_f32_32x32x16_bf16 v[48:63], v[116:119], v[76:79], v[48:63]
    v_subrev_u32 v94, 32768, v94
    v_subrev_u32 v95, 32768, v95
    ds_read_b64_tr_b16 v[112:113], v94 offset:0
    ds_read_b64_tr_b16 v[114:115], v94 offset:1024
    ds_read_b64_tr_b16 v[116:117], v95 offset:0
    ds_read_b64_tr_b16 v[118:119], v95 offset:1024
    buffer_load_dwordx4 v[168:171], v3, s[64:67], s93 offen sc1
    s_add_u32 s93, s93, 4096
    s_cmp_eq_u32 s93, 90112
    s_cselect_b32 s93, 0, s93
    s_add_u32 m0, s9, 131072
    s_nop 0
    buffer_load_dwordx4 v2, s[60:63], s92 offen lds
    s_add_u32 s92, s92, 65536
    s_bitset0_b32 s92, 19
    s_waitcnt vmcnt(10) lgkmcnt(12)
    v_mfma_f32_32x32x16_bf16 v[32:47], v[120:123], v[80:83], v[32:47]
    v_mfma_f32_32x32x16_bf16 v[48:63], v[124:127], v[80:83], v[48:63]
    s_setprio 1
    ds_read_b64_tr_b16 v[120:121], v94 offset:8192
    ds_read_b64_tr_b16 v[122:123], v94 offset:9216
    ds_read_b64_tr_b16 v[124:125], v95 offset:8192
    ds_read_b64_tr_b16 v[126:127], v95 offset:9216
    buffer_load_dwordx4 v[172:175], v3, s[64:67], s93 offen sc1
    s_add_u32 s93, s93, 4096
    s_cmp_eq_u32 s93, 90112
    s_cselect_b32 s93, 0, s93
    s_add_u32 m0, s9, 139264
    s_nop 0
    buffer_load_dwordx4 v2, s[60:63], s92 offen lds
    s_add_u32 s92, s92, 65536
    s_bitset0_b32 s92, 19
    s_waitcnt vmcnt(11) lgkmcnt(12)
    v_mfma_f32_32x32x16_bf16 v[32:47], v[96:99], v[84:87], v[32:47]
    v_mfma_f32_32x32x16_bf16 v[48:63], v[100:103], v[84:87], v[48:63]
    v_add_u32 v94, 32768, v94
    v_add_u32 v95, 32768, v95
    ds_read_b64_tr_b16 v[96:97], v94 offset:57344
    ds_read_b64_tr_b16 v[98:99], v94 offset:58368
    ds_read_b64_tr_b16 v[100:101], v95 offset:57344
    ds_read_b64_tr_b16 v[102:103], v95 offset:58368
    buffer_load_dwordx4 v[72:75], v3, s[64:67], s93 offen sc1
    s_add_u32 s93, s93, 4096
    s_cmp_eq_u32 s93, 90112
    s_cselect_b32 s93, 0, s93
    s_waitcnt vmcnt(10) lgkmcnt(12)
    v_mfma_f32_32x32x16_bf16 v[32:47], v[104:107], v[88:91], v[32:47]
    v_mfma_f32_32x32x16_bf16 v[48:63], v[108:111], v[88:91], v[48:63]
    v_subrev_u32 v94, 98304, v94
    v_subrev_u32 v95, 98304, v95
    ds_read_b64_tr_b16 v[104:105], v94 offset:0
    ds_read_b64_tr_b16 v[106:107], v94 offset:1024
    ds_read_b64_tr_b16 v[108:109], v95 offset:0
    ds_read_b64_tr_b16 v[110:111], v95 offset:1024
    buffer_load_dwordx4 v[160:163], v3, s[64:67], s93 offen sc1
    s_add_u32 s93, s93, 4096
    s_cmp_eq_u32 s93, 90112
    s_cselect_b32 s93, 0, s93
    s_waitcnt vmcnt(9) lgkmcnt(12)
    v_mfma_f32_32x32x16_bf16 v[32:47], v[112:115], v[144:147], v[32:47]
    v_mfma_f32_32x32x16_bf16 v[48:63], v[116:119], v[144:147], v[48:63]
    ds_read_b64_tr_b16 v[112:113], v94 offset:8192
    ds_read_b64_tr_b16 v[114:115], v94 offset:9216
    ds_read_b64_tr_b16 v[116:117], v95 offset:8192
    ds_read_b64_tr_b16 v[118:119], v95 offset:9216
    buffer_load_dwordx4 v[164:167], v3, s[64:67], s93 offen sc1
    s_add_u32 s93, s93, 4096
    s_cmp_eq_u32 s93, 90112
    s_cselect_b32 s93, 0, s93
    s_waitcnt vmcnt(8) lgkmcnt(12)
    v_mfma_f32_32x32x16_bf16 v[32:47], v[120:123], v[148:151], v[32:47]
    v_mfma_f32_32x32x16_bf16 v[48:63], v[124:127], v[148:151], v[48:63]
    s_cmp_lg_u32 s6, 0
    s_cbranch_scc1 L_g1
    ds_read_b64_tr_b16 v[120:121], v94 offset:16384
    ds_read_b64_tr_b16 v[122:123], v94 offset:17408
    ds_read_b64_tr_b16 v[124:125], v95 offset:16384
    ds_read_b64_tr_b16 v[126:127], v95 offset:17408
    v_add_u32 v92, 32, v92
    buffer_load_dwordx2 v[18:19], v92, s[64:67], 0 offen sc1
    s_lshr_b32 s3, s4, 1
    s_lshl_b32 s3, s3, 10
    s_add_u32 s3, s3, 98304
    v_add_u32 v4, s3, v3
    s_lshl_b32 s12, s94, 12
    buffer_load_dwordx4 v[128:131], v3, s[64:67], s93 offen sc1
    s_waitcnt vmcnt(8) lgkmcnt(12)
    v_mfma_f32_32x32x16_bf16 v[32:47], v[96:99], v[168:171], v[32:47]
    v_mfma_f32_32x32x16_bf16 v[48:63], v[100:103], v[168:171], v[48:63]
    ds_read_b64_tr_b16 v[96:97], v94 offset:24576
    ds_read_b64_tr_b16 v[98:99], v94 offset:25600
    ds_read_b64_tr_b16 v[100:101], v95 offset:24576
    ds_read_b64_tr_b16 v[102:103], v95 offset:25600
    s_waitcnt vmcnt(6) lgkmcnt(12)
    v_mfma_f32_32x32x16_bf16 v[32:47], v[104:107], v[172:175], v[32:47]
    v_mfma_f32_32x32x16_bf16 v[48:63], v[108:111], v[172:175], v[48:63]
    s_setprio 0
    ds_read_b64_tr_b16 v[104:105], v94 offset:32768
    ds_read_b64_tr_b16 v[106:107], v94 offset:33792
    ds_read_b64_tr_b16 v[108:109], v95 offset:32768
    ds_read_b64_tr_b16 v[110:111], v95 offset:33792
    s_waitcnt vmcnt(1)
    v_cmp_ne_u64 vcc, s[100:101], v[18:19]
    s_nop 0
    s_cbranch_vccnz L_rare_50
L_back_51:
    buffer_load_dwordx4 v[176:179], v4, s[64:67], s12 offen offset:0 sc1
    buffer_load_dwordx4 v[180:183], v4, s[64:67], s12 offen offset:1024 sc1
    s_add_u32 s12, s12, 4096
    s_bitset0_b32 s12, 15
    buffer_load_dwordx4 v[184:187], v4, s[64:67], s12 offen offset:0 sc1
    buffer_load_dwordx4 v[188:191], v4, s[64:67], s12 offen offset:1024 sc1
    s_add_u32 s12, s12, 4096
    s_bitset0_b32 s12, 15
    s_waitcnt vmcnt(8) lgkmcnt(12)
    v_mfma_f32_32x32x16_bf16 v[32:47], v[112:115], v[72:75], v[32:47]
    v_mfma_f32_32x32x16_bf16 v[48:63], v[116:119], v[72:75], v[48:63]
    s_waitcnt lgkmcnt(0)
    s_waitcnt vmcnt(9)
    s_barrier
    s_lshr_b32 s3, s4, 1
    s_lshl_b32 s3, s3, 11
    v_add_u32 v94, s3, v94
    v_add_u32 v95, s3, v95
    v_add_u32 v94, 81920, v94
    v_add_u32 v95, 81920, v95
    ds_read_b64_tr_b16 v[112:113], v94 offset:0
    ds_read_b64_tr_b16 v[114:115], v94 offset:1024
    ds_read_b64_tr_b16 v[116:117], v95 offset:0
    ds_read_b64_tr_b16 v[118:119], v95 offset:1024
    buffer_load_dwordx4 v[192:195], v4, s[64:67], s12 offen offset:0 sc1
    buffer_load_dwordx4 v[196:199], v4, s[64:67], s12 offen offset:1024 sc1
    s_add_u32 s12, s12, 4096
    s_bitset0_b32 s12, 15
    buffer_load_dwordx4 v[200:203], v4, s[64:67], s12 offen offset:0 sc1
    buffer_load_dwordx4 v[204:207], v4, s[64:67], s12 offen offset:1024 sc1
    s_add_u32 s12, s12, 4096
    s_bitset0_b32 s12, 15
    s_waitcnt vmcnt(11) lgkmcnt(12)
    v_mfma_f32_32x32x16_bf16 v[32:47], v[120:123], v[160:163], v[32:47]
    v_mfma_f32_32x32x16_bf16 v[48:63], v[124:127], v[160:163], v[48:63]
    ds_read_b64_tr_b16 v[120:121], v94 offset:2048
    ds_read_b64_tr_b16 v[122:123], v94 offset:3072
    ds_read_b64_tr_b16 v[124:125], v95 offset:2048
    ds_read_b64_tr_b16 v[126:127], v95 offset:3072
    buffer_load_dwordx4 v[208:211], v4, s[64:67], s12 offen offset:0 sc1
    buffer_load_dwordx4 v[212:215], v4, s[64:67], s12 offen offset:1024 sc1
    s_add_u32 s12, s12, 4096
    s_bitset0_b32 s12, 15
    buffer_load_dwordx4 v[216:219], v4, s[64:67], s12 offen offset:0 sc1
    buffer_load_dwordx4 v[220:223], v4, s[64:67], s12 offen offset:1024 sc1
    s_add_u32 s12, s12, 4096
    s_bitset0_b32 s12, 15
    s_waitcnt vmcnt(14) lgkmcnt(12)
    v_mfma_f32_32x32x16_bf16 v[32:47], v[96:99], v[164:167], v[32:47]
    v_mfma_f32_32x32x16_bf16 v[48:63], v[100:103], v[164:167], v[48:63]
    ds_read_b64_tr_b16 v[96:97], v94 offset:8192
    ds_read_b64_tr_b16 v[98:99], v94 offset:9216
    ds_read_b64_tr_b16 v[100:101], v95 offset:8192
    ds_read_b64_tr_b16 v[102:103], v95 offset:9216
    buffer_load_dwordx4 v[224:227], v4, s[64:67], s12 offen offset:0 sc1
    buffer_load_dwordx4 v[228:231], v4, s[64:67], s12 offen offset:1024 sc1
    s_add_u32 s12, s12, 4096
    s_bitset0_b32 s12, 15
    buffer_load_dwordx4 v[232:235], v4, s[64:67], s12 offen offset:0 sc1
    buffer_load_dwordx4 v[236:239], v4, s[64:67], s12 offen offset:1024 sc1
    s_add_u32 s12, s12, 4096
    s_bitset0_b32 s12, 15
    s_waitcnt vmcnt(16) lgkmcnt(12)
    v_mfma_f32_32x32x16_bf16 v[32:47], v[104:107], v[128:131], v[32:47]
    v_mfma_f32_32x32x16_bf16 v[48:63], v[108:111], v[128:131], v[48:63]
    ds_read_b64_tr_b16 v[104:105], v94 offset:10240
    ds_read_b64_tr_b16 v[106:107], v94 offset:11264
    ds_read_b64_tr_b16 v[108:109], v95 offset:10240
    ds_read_b64_tr_b16 v[110:111], v95 offset:11264
    s_waitcnt vmcnt(15) lgkmcnt(12)
    v_mfma_f32_32x32x16_bf16 v[32:47], v[112:115], v[176:179], v[32:47]
    v_mfma_f32_32x32x16_bf16 v[48:63], v[116:119], v[176:179], v[48:63]
    ds_read_b64_tr_b16 v[112:113], v94 offset:16384
    ds_read_b64_tr_b16 v[114:115], v94 offset:17408
    ds_read_b64_tr_b16 v[116:117], v95 offset:16384
    ds_read_b64_tr_b16 v[118:119], v95 offset:17408
    s_waitcnt vmcnt(14) lgkmcnt(12)
    v_mfma_f32_32x32x16_bf16 v[32:47], v[120:123], v[180:183], v[32:47]
    v_mfma_f32_32x32x16_bf16 v[48:63], v[124:127], v[180:183], v[48:63]
    ds_read_b64_tr_b16 v[120:121], v94 offset:18432
    ds_read_b64_tr_b16 v[122:123], v94 offset:19456
    ds_read_b64_tr_b16 v[124:125], v95 offset:18432
    ds_read_b64_tr_b16 v[126:127], v95 offset:19456
    s_waitcnt vmcnt(13) lgkmcnt(12)
    v_mfma_f32_32x32x16_bf16 v[32:47], v[96:99], v[184:187], v[32:47]
    v_mfma_f32_32x32x16_bf16 v[48:63], v[100:103], v[184:187], v[48:63]
    ds_read_b64_tr_b16 v[96:97], v94 offset:24576
    ds_read_b64_tr_b16 v[98:99], v94 offset:25600
    ds_read_b64_tr_b16 v[100:101], v95 offset:24576
    ds_read_b64_tr_b16 v[102:103], v95 offset:25600
    s_waitcnt vmcnt(12) lgkmcnt(12)
    v_mfma_f32_32x32x16_bf16 v[32:47], v[104:107], v[188:191], v[32:47]
    v_mfma_f32_32x32x16_bf16 v[48:63], v[108:111], v[188:191], v[48:63]
    ds_read_b64_tr_b16 v[104:105], v94 offset:26624
    ds_read_b64_tr_b16 v[106:107], v94 offset:27648
    ds_read_b64_tr_b16 v[108:109], v95 offset:26624
    ds_read_b64_tr_b16 v[110:111], v95 offset:27648
    s_waitcnt vmcnt(11) lgkmcnt(12)
    v_mfma_f32_32x32x16_bf16 v[32:47], v[112:115], v[192:195], v[32:47]
    v_mfma_f32_32x32x16_bf16 v[48:63], v[116:119], v[192:195], v[48:63]
    ds_read_b64_tr_b16 v[112:113], v94 offset:32768
    ds_read_b64_tr_b16 v[114:115], v94 offset:33792
    ds_read_b64_tr_b16 v[116:117], v95 offset:32768
    ds_read_b64_tr_b16 v[118:119], v95 offset:33792
    s_waitcnt vmcnt(10) lgkmcnt(12)
    v_mfma_f32_32x32x16_bf16 v[32:47], v[120:123], v[196:199], v[32:47]
    v_mfma_f32_32x32x16_bf16 v[48:63], v[124:127], v[196:199], v[48:63]
    ds_read_b64_tr_b16 v[120:121], v94 offset:34816
    ds_read_b64_tr_b16 v[122:123], v94 offset:35840
    ds_read_b64_tr_b16 v[124:125], v95 offset:34816
    ds_read_b64_tr_b16 v[126:127], v95 offset:35840
    s_waitcnt vmcnt(9) lgkmcnt(12)
    v_mfma_f32_32x32x16_bf16 v[32:47], v[96:99], v[200:203], v[32:47]
    v_mfma_f32_32x32x16_bf16 v[48:63], v[100:103], v[200:203], v[48:63]
    ds_read_b64_tr_b16 v[96:97], v94 offset:40960
    ds_read_b64_tr_b16 v[98:99], v94 offset:41984
    ds_read_b64_tr_b16 v[100:101], v95 offset:40960
    ds_read_b64_tr_b16 v[102:103], v95 offset:41984
    s_waitcnt vmcnt(8) lgkmcnt(12)
    v_mfma_f32_32x32x16_bf16 v[32:47], v[104:107], v[204:207], v[32:47]
    v_mfma_f32_32x32x16_bf16 v[48:63], v[108:111], v[204:207], v[48:63]
    ds_read_b64_tr_b16 v[104:105], v94 offset:43008
    ds_read_b64_tr_b16 v[106:107], v94 offset:44032
    ds_read_b64_tr_b16 v[108:109], v95 offset:43008
    ds_read_b64_tr_b16 v[110:111], v95 offset:44032
    s_waitcnt vmcnt(7) lgkmcnt(12)
    v_mfma_f32_32x32x16_bf16 v[32:47], v[112:115], v[208:211], v[32:47]
    v_mfma_f32_32x32x16_bf16 v[48:63], v[116:119], v[208:211], v[48:63]
    ds_read_b64_tr_b16 v[112:113], v94 offset:49152
    ds_read_b64_tr_b16 v[114:115], v94 offset:50176
    ds_read_b64_tr_b16 v[116:117], v95 offset:49152
    ds_read_b64_tr_b16 v[118:119], v95 offset:50176
    s_waitcnt vmcnt(6) lgkmcnt(12)
    v_mfma_f32_32x32x16_bf16 v[32:47], v[120:123], v[212:215], v[32:47]
    v_mfma_f32_32x32x16_bf16 v[48:63], v[124:127], v[212:215], v[48:63]
    ds_read_b64_tr_b16 v[120:121], v94 offset:51200
    ds_read_b64_tr_b16 v[122:123], v94 offset:52224
    ds_read_b64_tr_b16 v[124:125], v95 offset:51200
    ds_read_b64_tr_b16 v[126:127], v95 offset:52224
    s_waitcnt vmcnt(5) lgkmcnt(12)
    v_mfma_f32_32x32x16_bf16 v[32:47], v[96:99], v[216:219], v[32:47]
    v_mfma_f32_32x32x16_bf16 v[48:63], v[100:103], v[216:219], v[48:63]
    ds_read_b64_tr_b16 v[96:97], v94 offset:57344
    ds_read_b64_tr_b16 v[98:99], v94 offset:58368
    ds_read_b64_tr_b16 v[100:101], v95 offset:57344
    ds_read_b64_tr_b16 v[102:103], v95 offset:58368
    s_waitcnt vmcnt(4) lgkmcnt(12)
    v_mfma_f32_32x32x16_bf16 v[32:47], v[104:107], v[220:223], v[32:47]
    v_mfma_f32_32x32x16_bf16 v[48:63], v[108:111], v[220:223], v[48:63]
    ds_read_b64_tr_b16 v[104:105], v94 offset:59392
    ds_read_b64_tr_b16 v[106:107], v94 offset:60416
    ds_read_b64_tr_b16 v[108:109], v95 offset:59392
    ds_read_b64_tr_b16 v[110:111], v95 offset:60416
    s_waitcnt vmcnt(3) lgkmcnt(12)
    v_mfma_f32_32x32x16_bf16 v[32:47], v[112:115], v[224:227], v[32:47]
    v_mfma_f32_32x32x16_bf16 v[48:63], v[116:119], v[224:227], v[48:63]
    s_waitcnt vmcnt(2) lgkmcnt(8)
    v_mfma_f32_32x32x16_bf16 v[32:47], v[120:123], v[228:231], v[32:47]
    v_mfma_f32_32x32x16_bf16 v[48:63], v[124:127], v[228:231], v[48:63]
    s_waitcnt vmcnt(1) lgkmcnt(4)
    v_mfma_f32_32x32x16_bf16 v[32:47], v[96:99], v[232:235], v[32:47]
    v_mfma_f32_32x32x16_bf16 v[48:63], v[100:103], v[232:235], v[48:63]
    s_waitcnt vmcnt(0) lgkmcnt(0)
    v_mfma_f32_32x32x16_bf16 v[32:47], v[104:107], v[236:239], v[32:47]
    v_mfma_f32_32x32x16_bf16 v[48:63], v[108:111], v[236:239], v[48:63]
    s_branch L_dep
L_g1:
    ds_read_b64_tr_b16 v[120:121], v94 offset:16384
    ds_read_b64_tr_b16 v[122:123], v94 offset:17408
    ds_read_b64_tr_b16 v[124:125], v95 offset:16384
    ds_read_b64_tr_b16 v[126:127], v95 offset:17408
    buffer_load_dwordx4 v[128:131], v3, s[64:67], s93 offen sc1
    s_waitcnt vmcnt(7) lgkmcnt(12)
    v_mfma_f32_32x32x16_bf16 v[32:47], v[96:99], v[168:171], v[32:47]
    v_mfma_f32_32x32x16_bf16 v[48:63], v[100:103], v[168:171], v[48:63]
    ds_read_b64_tr_b16 v[96:97], v94 offset:24576
    ds_read_b64_tr_b16 v[98:99], v94 offset:25600
    ds_read_b64_tr_b16 v[100:101], v95 offset:24576
    ds_read_b64_tr_b16 v[102:103], v95 offset:25600
    s_waitcnt vmcnt(5) lgkmcnt(12)
    v_mfma_f32_32x32x16_bf16 v[32:47], v[104:107], v[172:175], v[32:47]
    v_mfma_f32_32x32x16_bf16 v[48:63], v[108:111], v[172:175], v[48:63]
    s_lshl_b32 s12, s2, 3
    s_add_u32 s12, s12, s4
    s_cmp_eq_u32 s12, 460
    s_cbranch_scc1 L_rare_53
L_back_54:
    s_setprio 0
    ds_read_b64_tr_b16 v[104:105], v94 offset:32768
    ds_read_b64_tr_b16 v[106:107], v94 offset:33792
    ds_read_b64_tr_b16 v[108:109], v95 offset:32768
    ds_read_b64_tr_b16 v[110:111], v95 offset:33792
    s_waitcnt vmcnt(3) lgkmcnt(12)
    v_mfma_f32_32x32x16_bf16 v[32:47], v[112:115], v[72:75], v[32:47]
    v_mfma_f32_32x32x16_bf16 v[48:63], v[116:119], v[72:75], v[48:63]
    s_waitcnt lgkmcnt(0)
    s_waitcnt vmcnt(4)
    s_barrier
    s_waitcnt vmcnt(2) lgkmcnt(8)
    v_mfma_f32_32x32x16_bf16 v[32:47], v[120:123], v[160:163], v[32:47]
    v_mfma_f32_32x32x16_bf16 v[48:63], v[124:127], v[160:163], v[48:63]
    s_waitcnt vmcnt(1) lgkmcnt(4)
    v_mfma_f32_32x32x16_bf16 v[32:47], v[96:99], v[164:167], v[32:47]
    v_mfma_f32_32x32x16_bf16 v[48:63], v[100:103], v[164:167], v[48:63]
    s_waitcnt vmcnt(0) lgkmcnt(0)
    v_mfma_f32_32x32x16_bf16 v[32:47], v[104:107], v[128:131], v[32:47]
    v_mfma_f32_32x32x16_bf16 v[48:63], v[108:111], v[128:131], v[48:63]
    s_cmp_eq_u32 s12, 460
    s_cbranch_scc1 L_rare_55
L_back_56:
L_dep:
    s_nop 9
    ds_write_b128 v152, v[32:35] offset:0
    ds_write_b128 v153, v[36:39] offset:0
    ds_write_b128 v154, v[40:43] offset:0
    ds_write_b128 v155, v[44:47] offset:0
    ds_write_b128 v152, v[48:51] offset:128
    ds_write_b128 v153, v[52:55] offset:128
    ds_write_b128 v154, v[56:59] offset:128
    ds_write_b128 v155, v[60:63] offset:128
    s_waitcnt lgkmcnt(0)
    s_barrier
    ds_read_b128 v[96:99], v30 offset:0
    ds_read_b128 v[100:103], v31 offset:0
    ds_read_b128 v[104:107], v30 offset:16384
    ds_read_b128 v[108:111], v31 offset:16384
    ds_read_b128 v[112:115], v30 offset:32768
    ds_read_b128 v[116:119], v31 offset:32768
    ds_read_b128 v[120:123], v30 offset:49152
    ds_read_b128 v[124:127], v31 offset:49152
    s_waitcnt lgkmcnt(4)
    v_pk_add_f32 v[96:97], v[96:97], v[104:105]
    v_pk_add_f32 v[98:99], v[98:99], v[106:107]
    v_pk_add_f32 v[100:101], v[100:101], v[108:109]
    v_pk_add_f32 v[102:103], v[102:103], v[110:111]
    s_waitcnt lgkmcnt(0)
    v_pk_add_f32 v[112:113], v[112:113], v[120:121]
    v_pk_add_f32 v[114:115], v[114:115], v[122:123]
    v_pk_add_f32 v[116:117], v[116:117], v[124:125]
    v_pk_add_f32 v[118:119], v[118:119], v[126:127]
    v_pk_add_f32 v[96:97], v[96:97], v[112:113]
    v_pk_add_f32 v[98:99], v[98:99], v[114:115]
    v_pk_add_f32 v[100:101], v[100:101], v[116:117]
    v_pk_add_f32 v[102:103], v[102:103], v[118:119]
    v_cvt_pk_bf16_f32 v104, v96, v97
    v_cvt_pk_bf16_f32 v105, v98, v99
    v_cvt_pk_bf16_f32 v106, v100, v101
    v_cvt_pk_bf16_f32 v107, v102, v103
    buffer_store_dwordx4 v[104:107], v28, s[68:71], s89 offen sc1 nt
L_end:
    s_endpgm
.p2align 6
L_masks:
.long 0xffffffff, 0xfffffff0
.long 0xfffffffe, 0xffffffe0
.long 0xfffffffc, 0xffffffc0
.long 0xfffffff8, 0xffffff80
.long 0xffffff00, 0xfffff000
.long 0xfffffe00, 0xffffe000
.long 0xfffffc00, 0xffffc000
.long 0xfffff800, 0xffff8000
.long 0xffff0000, 0xfff00000
.long 0xfffe0000, 0xffe00000
.long 0xfffc0000, 0xffc00000
.long 0xfff80000, 0xff800000
.long 0xff000000, 0xf0000000
.long 0xfe000000, 0xe0000000
.long 0xfc000000, 0xc0000000
.long 0xf8000000, 0x80000000
L_rare_17:
    s_nop 0
L_poll_57:
    buffer_load_dwordx2 v[136:137], v93, s[64:67], 0 offen sc1
    s_waitcnt vmcnt(0)
    v_cmp_ne_u64 vcc, s[100:101], v[136:137]
    s_nop 0
    s_cbranch_vccz L_polld_58
    s_sleep 2
    s_sub_u32 s73, s73, 1
    s_cbranch_scc0 L_poll_57
    s_mov_b32 s73, 0
L_polld_58:
    s_nop 0
    s_branch L_back_18
L_rare_19:
    s_nop 0
    v_mov_b64 v[200:201], 0
    v_mov_b64 v[202:203], 0
    s_nop 0
    s_branch L_back_20
L_rare_21:
    s_nop 0
    v_mov_b64 v[204:205], 0
    v_mov_b64 v[206:207], 0
    s_nop 0
    s_branch L_back_22
L_rare_23:
    s_nop 7
    v_mov_b32 v28, 0xff800000
    v_mov_b32 v29, 0xff800000
    v_mov_b64 v[96:97], v[28:29]
    v_mov_b64 v[98:99], v[28:29]
    v_mov_b64 v[100:101], v[28:29]
    v_mov_b64 v[102:103], v[28:29]
    v_mov_b64 v[104:105], v[28:29]
    v_mov_b64 v[106:107], v[28:29]
    v_mov_b64 v[108:109], v[28:29]
    v_mov_b64 v[110:111], v[28:29]
    s_nop 1
    s_branch L_back_24
L_rare_25:
    s_nop 12
    v_mov_b32 v28, 0xff800000
    v_mov_b32 v29, 0xff800000
    v_mov_b64 v[128:129], v[28:29]
    v_mov_b64 v[130:131], v[28:29]
    v_mov_b64 v[132:133], v[28:29]
    v_mov_b64 v[134:135], v[28:29]
    v_mov_b64 v[136:137], v[28:29]
    v_mov_b64 v[138:139], v[28:29]
    v_mov_b64 v[140:141], v[28:29]
    v_mov_b64 v[142:143], v[28:29]
    s_nop 0
    s_branch L_back_26
L_rare_27:
    s_nop 7
    v_mov_b32 v28, 0xff800000
    v_mov_b32 v29, 0xff800000
    v_mov_b64 v[96:97], v[28:29]
    v_mov_b64 v[98:99], v[28:29]
    v_mov_b64 v[100:101], v[28:29]
    v_mov_b64 v[102:103], v[28:29]
    v_mov_b64 v[104:105], v[28:29]
    v_mov_b64 v[106:107], v[28:29]
    v_mov_b64 v[108:109], v[28:29]
    v_mov_b64 v[110:111], v[28:29]
    s_nop 1
    s_branch L_back_28
L_rare_29:
    s_nop 7
    v_mov_b32 v28, 0xff800000
    v_mov_b32 v29, 0xff800000
    v_mov_b64 v[96:97], v[28:29]
    v_mov_b64 v[98:99], v[28:29]
    v_mov_b64 v[100:101], v[28:29]
    v_mov_b64 v[102:103], v[28:29]
    v_mov_b64 v[104:105], v[28:29]
    v_mov_b64 v[106:107], v[28:29]
    v_mov_b64 v[108:109], v[28:29]
    v_mov_b64 v[110:111], v[28:29]
    s_nop 1
    s_branch L_back_30
L_rare_31:
    s_nop 7
    v_mov_b32 v28, 0xff800000
    v_mov_b32 v29, 0xff800000
    v_mov_b64 v[96:97], v[28:29]
    v_mov_b64 v[98:99], v[28:29]
    v_mov_b64 v[100:101], v[28:29]
    v_mov_b64 v[102:103], v[28:29]
    v_mov_b64 v[104:105], v[28:29]
    v_mov_b64 v[106:107], v[28:29]
    v_mov_b64 v[108:109], v[28:29]
    v_mov_b64 v[110:111], v[28:29]
    s_nop 1
    s_branch L_back_32
L_rare_33:
    s_nop 7
    v_mov_b32 v28, 0xff800000
    v_mov_b32 v29, 0xff800000
    v_mov_b64 v[96:97], v[28:29]
    v_mov_b64 v[98:99], v[28:29]
    v_mov_b64 v[100:101], v[28:29]
    v_mov_b64 v[102:103], v[28:29]
    v_mov_b64 v[104:105], v[28:29]
    v_mov_b64 v[106:107], v[28:29]
    v_mov_b64 v[108:109], v[28:29]
    v_mov_b64 v[110:111], v[28:29]
    s_nop 1
    s_branch L_back_34
L_rare_35:
    s_nop 7
    v_mov_b32 v28, 0xff800000
    v_mov_b32 v29, 0xff800000
    v_mov_b64 v[96:97], v[28:29]
    v_mov_b64 v[98:99], v[28:29]
    v_mov_b64 v[100:101], v[28:29]
    v_mov_b64 v[102:103], v[28:29]
    v_mov_b64 v[104:105], v[28:29]
    v_mov_b64 v[106:107], v[28:29]
    v_mov_b64 v[108:109], v[28:29]
    v_mov_b64 v[110:111], v[28:29]
    s_nop 1
    s_branch L_back_36
L_rare_37:
    s_nop 0
    s_cmp_eq_u32 s75, 1
    s_cbranch_scc1 L_e2_61
    v_cmp_ne_u64 vcc, s[100:101], v[18:19]
    s_nop 0
    s_cbranch_vccnz L_ne_59
    buffer_load_dwordx4 v[168:171], v3, s[64:67], s93 offen sc1
    s_add_u32 s93, s93, 4096
    s_cmp_eq_u32 s93, 90112
    s_cselect_b32 s93, 0, s93
    buffer_load_dwordx4 v[172:175], v3, s[64:67], s93 offen sc1
    s_add_u32 s93, s93, 4096
    s_cmp_eq_u32 s93, 90112
    s_cselect_b32 s93, 0, s93
    buffer_load_dwordx4 v[72:75], v3, s[64:67], s93 offen sc1
    s_add_u32 s93, s93, 4096
    s_cmp_eq_u32 s93, 90112
    s_cselect_b32 s93, 0, s93
    s_mov_b32 s75, 1
    s_branch L_ee_60
L_e2_61:
    buffer_load_dwordx4 v[160:163], v3, s[64:67], s93 offen sc1
    s_add_u32 s93, s93, 4096
    s_cmp_eq_u32 s93, 90112
    s_cselect_b32 s93, 0, s93
    buffer_load_dwordx4 v[164:167], v3, s[64:67], s93 offen sc1
    s_add_u32 s93, s93, 4096
    s_cmp_eq_u32 s93, 90112
    s_cselect_b32 s93, 0, s93
    buffer_load_dwordx4 v[128:131], v3, s[64:67], s93 offen sc1
    s_add_u32 s93, s93, 4096
    s_cmp_eq_u32 s93, 90112
    s_cselect_b32 s93, 0, s93
    s_mov_b32 s75, 2
    s_branch L_ee_60
L_ne_59:
    buffer_load_dwordx2 v[18:19], v92, s[64:67], 0 offen sc1
L_ee_60:
    s_nop 0
    s_branch L_back_38
L_rare_39:
    s_nop 7
    v_mov_b32 v28, 0xff800000
    v_mov_b32 v29, 0xff800000
    v_mov_b64 v[96:97], v[28:29]
    v_mov_b64 v[98:99], v[28:29]
    v_mov_b64 v[100:101], v[28:29]
    v_mov_b64 v[102:103], v[28:29]
    v_mov_b64 v[104:105], v[28:29]
    v_mov_b64 v[106:107], v[28:29]
    v_mov_b64 v[108:109], v[28:29]
    v_mov_b64 v[110:111], v[28:29]
    s_nop 1
    s_branch L_back_40
L_rare_41:
    s_nop 0
    s_cmp_eq_u32 s75, 1
    s_cbranch_scc1 L_e2_64
    v_cmp_ne_u64 vcc, s[100:101], v[18:19]
    s_nop 0
    s_cbranch_vccnz L_ne_62
    buffer_load_dwordx4 v[168:171], v3, s[64:67], s93 offen sc1
    s_add_u32 s93, s93, 4096
    s_cmp_eq_u32 s93, 90112
    s_cselect_b32 s93, 0, s93
    buffer_load_dwordx4 v[172:175], v3, s[64:67], s93 offen sc1
    s_add_u32 s93, s93, 4096
    s_cmp_eq_u32 s93, 90112
    s_cselect_b32 s93, 0, s93
    buffer_load_dwordx4 v[72:75], v3, s[64:67], s93 offen sc1
    s_add_u32 s93, s93, 4096
    s_cmp_eq_u32 s93, 90112
    s_cselect_b32 s93, 0, s93
    s_mov_b32 s75, 1
    s_branch L_ee_63
L_e2_64:
    buffer_load_dwordx4 v[160:163], v3, s[64:67], s93 offen sc1
    s_add_u32 s93, s93, 4096
    s_cmp_eq_u32 s93, 90112
    s_cselect_b32 s93, 0, s93
    buffer_load_dwordx4 v[164:167], v3, s[64:67], s93 offen sc1
    s_add_u32 s93, s93, 4096
    s_cmp_eq_u32 s93, 90112
    s_cselect_b32 s93, 0, s93
    buffer_load_dwordx4 v[128:131], v3, s[64:67], s93 offen sc1
    s_add_u32 s93, s93, 4096
    s_cmp_eq_u32 s93, 90112
    s_cselect_b32 s93, 0, s93
    s_mov_b32 s75, 2
    s_branch L_ee_63
L_ne_62:
    buffer_load_dwordx2 v[18:19], v92, s[64:67], 0 offen sc1
L_ee_63:
    s_nop 0
    s_branch L_back_42
L_rare_43:
    s_nop 0
    s_cmp_eq_u32 s75, 1
    s_cbranch_scc1 L_e2_67
    v_cmp_ne_u64 vcc, s[100:101], v[18:19]
    s_nop 0
    s_cbranch_vccnz L_ne_65
    buffer_load_dwordx4 v[168:171], v3, s[64:67], s93 offen sc1
    s_add_u32 s93, s93, 4096
    s_cmp_eq_u32 s93, 90112
    s_cselect_b32 s93, 0, s93
    buffer_load_dwordx4 v[172:175], v3, s[64:67], s93 offen sc1
    s_add_u32 s93, s93, 4096
    s_cmp_eq_u32 s93, 90112
    s_cselect_b32 s93, 0, s93
    buffer_load_dwordx4 v[72:75], v3, s[64:67], s93 offen sc1
    s_add_u32 s93, s93, 4096
    s_cmp_eq_u32 s93, 90112
    s_cselect_b32 s93, 0, s93
    s_mov_b32 s75, 1
    s_branch L_ee_66
L_e2_67:
    buffer_load_dwordx4 v[160:163], v3, s[64:67], s93 offen sc1
    s_add_u32 s93, s93, 4096
    s_cmp_eq_u32 s93, 90112
    s_cselect_b32 s93, 0, s93
    buffer_load_dwordx4 v[164:167], v3, s[64:67], s93 offen sc1
    s_add_u32 s93, s93, 4096
    s_cmp_eq_u32 s93, 90112
    s_cselect_b32 s93, 0, s93
    buffer_load_dwordx4 v[128:131], v3, s[64:67], s93 offen sc1
    s_add_u32 s93, s93, 4096
    s_cmp_eq_u32 s93, 90112
    s_cselect_b32 s93, 0, s93
    s_mov_b32 s75, 2
    s_branch L_ee_66
L_ne_65:
    buffer_load_dwordx2 v[18:19], v92, s[64:67], 0 offen sc1
L_ee_66:
    s_nop 0
    s_branch L_back_44
L_rare_47:
    s_nop 0
    s_cmp_eq_u32 s75, 1
    s_cbranch_scc1 L_l2_70
    s_waitcnt vmcnt(0)
    v_cmp_ne_u64 vcc, s[100:101], v[18:19]
    s_nop 0
    s_cbranch_vccz L_polld_69
    buffer_store_dwordx4 v[64:67], v1, s[64:67], s86 offen sc1
    buffer_load_dwordx2 v[18:19], v92, s[64:67], 0 offen sc1
    s_waitcnt vmcnt(1)
    v_mov_b64 v[28:29], s[100:101]
    s_mov_b64 exec, 1
    buffer_store_dwordx2 v[28:29], off, s[64:67], s83 sc1
    s_mov_b64 exec, -1
    s_waitcnt vmcnt(1)
    v_cmp_ne_u64 vcc, s[100:101], v[18:19]
    s_nop 0
    s_cbranch_vccz L_polld_69
L_poll_68:
    buffer_load_dwordx2 v[18:19], v92, s[64:67], 0 offen sc1
    s_waitcnt vmcnt(0)
    v_cmp_ne_u64 vcc, s[100:101], v[18:19]
    s_nop 0
    s_cbranch_vccz L_polld_69
    s_sleep 2
    s_sub_u32 s73, s73, 1
    s_cbranch_scc0 L_poll_68
    s_mov_b32 s73, 0
L_polld_69:
    buffer_load_dwordx4 v[168:171], v3, s[64:67], s93 offen sc1
    s_add_u32 s93, s93, 4096
    s_cmp_eq_u32 s93, 90112
    s_cselect_b32 s93, 0, s93
    buffer_load_dwordx4 v[172:175], v3, s[64:67], s93 offen sc1
    s_add_u32 s93, s93, 4096
    s_cmp_eq_u32 s93, 90112
    s_cselect_b32 s93, 0, s93
    buffer_load_dwordx4 v[72:75], v3, s[64:67], s93 offen sc1
    s_add_u32 s93, s93, 4096
    s_cmp_eq_u32 s93, 90112
    s_cselect_b32 s93, 0, s93
L_l2_70:
    buffer_load_dwordx4 v[160:163], v3, s[64:67], s93 offen sc1
    s_add_u32 s93, s93, 4096
    s_cmp_eq_u32 s93, 90112
    s_cselect_b32 s93, 0, s93
    buffer_load_dwordx4 v[164:167], v3, s[64:67], s93 offen sc1
    s_add_u32 s93, s93, 4096
    s_cmp_eq_u32 s93, 90112
    s_cselect_b32 s93, 0, s93
    buffer_load_dwordx4 v[128:131], v3, s[64:67], s93 offen sc1
    s_add_u32 s93, s93, 4096
    s_cmp_eq_u32 s93, 90112
    s_cselect_b32 s93, 0, s93
    s_nop 0
    s_branch L_back_48
L_rare_50:
    s_nop 0
L_poll_71:
    buffer_load_dwordx2 v[18:19], v92, s[64:67], 0 offen sc1
    s_waitcnt vmcnt(0)
    v_cmp_ne_u64 vcc, s[100:101], v[18:19]
    s_nop 0
    s_cbranch_vccz L_polld_72
    s_sleep 2
    s_sub_u32 s73, s73, 1
    s_cbranch_scc0 L_poll_71
    s_mov_b32 s73, 0
L_polld_72:
    s_nop 0
    s_branch L_back_51
L_rare_53:
    s_nop 0
    v_lshrrev_b32 v176, 4, v0
    v_and_b32 v177, 15, v0
    v_lshl_add_u32 v176, v176, 5, v177
    v_lshlrev_b32 v176, 7, v176
    v_add_u32 v176, 65536, v176
    s_mov_b32 s3, 0
    buffer_load_dwordx2 v[178:179], v176, s[64:67], s3 offen sc1
    s_add_u32 s3, s3, 16384
    buffer_load_dwordx2 v[180:181], v176, s[64:67], s3 offen sc1
    s_add_u32 s3, s3, 16384
    buffer_load_dwordx2 v[182:183], v176, s[64:67], s3 offen sc1
    s_add_u32 s3, s3, 16384
    buffer_load_dwordx2 v[184:185], v176, s[64:67], s3 offen sc1
    s_add_u32 s3, s3, 16384
    s_nop 1
    s_branch L_back_54
L_rare_55:
    s_nop 0
L_zp_73:
    s_waitcnt vmcnt(0)
    v_cmp_ne_u64 vcc, s[100:101], v[178:179]
    v_cmp_ne_u64 s[0:1], s[100:101], v[180:181]
    s_nop 0
    s_or_b64 vcc, vcc, s[0:1]
    v_cmp_ne_u64 s[0:1], s[100:101], v[182:183]
    s_nop 0
    s_or_b64 vcc, vcc, s[0:1]
    v_cmp_ne_u64 s[0:1], s[100:101], v[184:185]
    s_nop 0
    s_or_b64 vcc, vcc, s[0:1]
    s_cbranch_scc0 L_zd_74
    s_mov_b32 s3, 0
    buffer_load_dwordx2 v[178:179], v176, s[64:67], s3 offen sc1
    s_add_u32 s3, s3, 16384
    buffer_load_dwordx2 v[180:181], v176, s[64:67], s3 offen sc1
    s_add_u32 s3, s3, 16384
    buffer_load_dwordx2 v[182:183], v176, s[64:67], s3 offen sc1
    s_add_u32 s3, s3, 16384
    buffer_load_dwordx2 v[184:185], v176, s[64:67], s3 offen sc1
    s_add_u32 s3, s3, 16384
    s_sub_u32 s73, s73, 1
    s_cbranch_scc0 L_zp_73
    s_mov_b32 s73, 0
L_zd_74:
    v_mov_b32 v176, s100
    s_mov_b64 exec, 1
    buffer_store_dword v176, off, s[64:67], 0 sc1
    s_mov_b64 exec, -1
    s_nop 1
    s_branch L_back_56
L_hot_end:
L_rare_45:
    s_nop 0
    s_waitcnt vmcnt(0)
    s_mov_b32 s75, 0
    s_mov_b32 s93, s90
    v_mov_b32 v28, 0xffff
    v_cndmask_b32 v160, 0, v28, s[16:17]
    v_cndmask_b32 v160, v160, -1, s[18:19]
    v_cndmask_b32 v161, 0, v28, s[20:21]
    v_cndmask_b32 v161, v161, -1, s[22:23]
    v_cndmask_b32 v162, 0, v28, s[24:25]
    v_cndmask_b32 v162, v162, -1, s[26:27]
    v_cndmask_b32 v163, 0, v28, s[28:29]
    v_cndmask_b32 v163, v163, -1, s[30:31]
    v_cndmask_b32 v164, 0, v28, s[32:33]
    v_cndmask_b32 v164, v164, -1, s[34:35]
    v_cndmask_b32 v165, 0, v28, s[36:37]
    v_cndmask_b32 v165, v165, -1, s[38:39]
    v_cndmask_b32 v166, 0, v28, s[40:41]
    v_cndmask_b32 v166, v166, -1, s[42:43]
    v_cndmask_b32 v167, 0, v28, s[44:45]
    v_cndmask_b32 v167, v167, -1, s[46:47]
    ds_read_b128 v[144:147], v8 offset:8192
    ds_read_b128 v[148:151], v8 offset:0
    ds_read_b128 v[152:155], v8 offset:7168
    v_mov_b64 v[96:97], 0
    v_mov_b64 v[98:99], 0
    v_mov_b64 v[100:101], 0
    v_mov_b64 v[102:103], 0
    v_mov_b64 v[104:105], 0
    v_mov_b64 v[106:107], 0
    v_mov_b64 v[108:109], 0
    v_mov_b64 v[110:111], 0
    s_waitcnt lgkmcnt(2)
    s_nop 0
    v_mfma_f32_32x32x16_bf16 v[32:47], v[144:147], v[156:159], v[96:111]
    ds_read_b128 v[144:147], v8 offset:6144
    s_waitcnt lgkmcnt(2)
    v_mfma_f32_32x32x16_bf16 v[128:143], v[148:151], v[156:159], v[96:111]
    ds_read_b128 v[148:151], v8 offset:5120
    s_waitcnt lgkmcnt(2)
    s_cmp_eq_u32 s88, 8
    s_cbranch_scc1 L_rare_75
L_back_76:
    v_mfma_f32_32x32x16_bf16 v[48:63], v[152:155], v[156:159], v[96:111]
    ds_read_b128 v[152:155], v8 offset:4096
    s_cmp_gt_u32 s88, 0
    s_cbranch_scc1 L_rare_77
L_back_78:
    s_nop 3
    v_cndmask_b32 v32, v128, v32, s[16:17]
    v_cndmask_b32 v33, v129, v33, s[18:19]
    v_cndmask_b32 v34, v130, v34, s[20:21]
    v_cndmask_b32 v35, v131, v35, s[22:23]
    v_cndmask_b32 v36, v132, v36, s[24:25]
    v_cndmask_b32 v37, v133, v37, s[26:27]
    v_cndmask_b32 v38, v134, v38, s[28:29]
    v_cndmask_b32 v39, v135, v39, s[30:31]
    v_cndmask_b32 v40, v136, v40, s[32:33]
    v_cndmask_b32 v41, v137, v41, s[34:35]
    v_cndmask_b32 v42, v138, v42, s[36:37]
    v_cndmask_b32 v43, v139, v43, s[38:39]
    v_cndmask_b32 v44, v140, v44, s[40:41]
    v_cndmask_b32 v45, v141, v45, s[42:43]
    v_cndmask_b32 v46, v142, v46, s[44:45]
    v_cndmask_b32 v47, v143, v47, s[46:47]
    v_max_f32 v16, v32, v33
    v_max_f32 v17, v34, v35
    v_max3_f32 v16, v36, v37, v16
    v_max3_f32 v17, v38, v39, v17
    v_max3_f32 v16, v40, v41, v16
    v_max3_f32 v17, v42, v43, v17
    v_max3_f32 v16, v44, v45, v16
    v_max3_f32 v17, v46, v47, v17
    s_waitcnt lgkmcnt(2)
    s_cmp_eq_u32 s88, 7
    s_cbranch_scc1 L_rare_79
L_back_80:
    v_mfma_f32_32x32x16_bf16 v[32:47], v[144:147], v[156:159], v[96:111]
    ds_read_b128 v[144:147], v8 offset:3072
    v_max3_f32 v16, v48, v49, v16
    v_max3_f32 v17, v50, v51, v17
    v_max3_f32 v16, v52, v53, v16
    v_max3_f32 v17, v54, v55, v17
    v_max3_f32 v16, v56, v57, v16
    v_max3_f32 v17, v58, v59, v17
    v_max3_f32 v16, v60, v61, v16
    v_max3_f32 v17, v62, v63, v17
    s_waitcnt lgkmcnt(2)
    s_cmp_eq_u32 s88, 6
    s_cbranch_scc1 L_rare_81
L_back_82:
    v_mfma_f32_32x32x16_bf16 v[48:63], v[148:151], v[156:159], v[96:111]
    ds_read_b128 v[148:151], v8 offset:2048
    v_max3_f32 v16, v32, v33, v16
    v_max3_f32 v17, v34, v35, v17
    v_max3_f32 v16, v36, v37, v16
    v_max3_f32 v17, v38, v39, v17
    v_max3_f32 v16, v40, v41, v16
    v_max3_f32 v17, v42, v43, v17
    v_max3_f32 v16, v44, v45, v16
    v_max3_f32 v17, v46, v47, v17
    s_waitcnt lgkmcnt(2)
    s_cmp_eq_u32 s88, 5
    s_cbranch_scc1 L_rare_83
L_back_84:
    v_mfma_f32_32x32x16_bf16 v[32:47], v[152:155], v[156:159], v[96:111]
    ds_read_b128 v[152:155], v8 offset:1024
    v_max3_f32 v16, v48, v49, v16
    v_max3_f32 v17, v50, v51, v17
    v_max3_f32 v16, v52, v53, v16
    v_max3_f32 v17, v54, v55, v17
    v_max3_f32 v16, v56, v57, v16
    v_max3_f32 v17, v58, v59, v17
    v_max3_f32 v16, v60, v61, v16
    v_max3_f32 v17, v62, v63, v17
    s_waitcnt lgkmcnt(2)
    s_cmp_eq_u32 s88, 4
    s_cbranch_scc1 L_rare_85
L_back_86:
    v_mfma_f32_32x32x16_bf16 v[48:63], v[144:147], v[156:159], v[96:111]
    v_max3_f32 v16, v32, v33, v16
    v_max3_f32 v17, v34, v35, v17
    v_max3_f32 v16, v36, v37, v16
    v_max3_f32 v17, v38, v39, v17
    v_max3_f32 v16, v40, v41, v16
    v_max3_f32 v17, v42, v43, v17
    v_max3_f32 v16, v44, v45, v16
    v_max3_f32 v17, v46, v47, v17
    s_waitcnt lgkmcnt(1)
    s_cmp_eq_u32 s88, 3
    s_cbranch_scc1 L_rare_87
L_back_88:
    v_mfma_f32_32x32x16_bf16 v[32:47], v[148:151], v[156:159], v[96:111]
    v_max3_f32 v16, v48, v49, v16
    v_max3_f32 v17, v50, v51, v17
    v_max3_f32 v16, v52, v53, v16
    v_max3_f32 v17, v54, v55, v17
    v_max3_f32 v16, v56, v57, v16
    v_max3_f32 v17, v58, v59, v17
    v_max3_f32 v16, v60, v61, v16
    v_max3_f32 v17, v62, v63, v17
    s_waitcnt lgkmcnt(0)
    s_cmp_eq_u32 s88, 2
    s_cbranch_scc1 L_rare_89
L_back_90:
    v_mfma_f32_32x32x16_bf16 v[48:63], v[152:155], v[156:159], v[96:111]
    v_max3_f32 v16, v32, v33, v16
    v_max3_f32 v17, v34, v35, v17
    v_max3_f32 v16, v36, v37, v16
    v_max3_f32 v17, v38, v39, v17
    v_max3_f32 v16, v40, v41, v16
    v_max3_f32 v17, v42, v43, v17
    v_max3_f32 v16, v44, v45, v16
    v_max3_f32 v17, v46, v47, v17
    s_nop 3
    v_max3_f32 v16, v48, v49, v16
    v_max3_f32 v17, v50, v51, v17
    v_max3_f32 v16, v52, v53, v16
    v_max3_f32 v17, v54, v55, v17
    v_max3_f32 v16, v56, v57, v16
    v_max3_f32 v17, v58, v59, v17
    v_max3_f32 v16, v60, v61, v16
    v_max3_f32 v17, v62, v63, v17
    v_max_f32 v16, v16, v17
    v_mov_b32 v28, v16
    s_nop 1
    v_permlane32_swap_b32 v16, v28
    v_max_f32 v16, v16, v28
    v_sub_f32 v16, 0, v16
    v_mov_b32 v17, v16
    ds_read_b128 v[144:147], v8 offset:8192
    ds_read_b128 v[148:151], v8 offset:0
    ds_read_b128 v[152:155], v8 offset:7168
    v_mov_b64 v[96:97], v[16:17]
    v_mov_b64 v[98:99], v[16:17]
    v_mov_b64 v[100:101], v[16:17]
    v_mov_b64 v[102:103], v[16:17]
    v_mov_b64 v[104:105], v[16:17]
    v_mov_b64 v[106:107], v[16:17]
    v_mov_b64 v[108:109], v[16:17]
    v_mov_b64 v[110:111], v[16:17]
    s_mov_b64 exec, s[96:97]
    ds_read_b128 v[76:79], v9 offset:16384
    ds_read_b128 v[80:83], v9 offset:17408
    s_mov_b64 exec, -1
    s_mov_b64 exec, s[96:97]
    ds_read_b128 v[84:87], v9 offset:0
    ds_read_b128 v[88:91], v9 offset:1024
    s_mov_b64 exec, -1
    s_waitcnt lgkmcnt(6)
    v_mfma_f32_32x32x16_bf16 v[32:47], v[144:147], v[156:159], v[96:111]
    ds_read_b128 v[144:147], v8 offset:6144
    s_waitcnt lgkmcnt(6)
    v_mfma_f32_32x32x16_bf16 v[128:143], v[148:151], v[156:159], v[96:111]
    ds_read_b128 v[148:151], v8 offset:5120
    s_waitcnt lgkmcnt(6)
    s_cmp_eq_u32 s88, 8
    s_cbranch_scc1 L_rare_91
L_back_92:
    v_mfma_f32_32x32x16_bf16 v[48:63], v[152:155], v[156:159], v[96:111]
    ds_read_b128 v[152:155], v8 offset:4096
    s_cmp_gt_u32 s88, 0
    s_cbranch_scc1 L_rare_93
L_back_94:
    s_nop 3
    v_cndmask_b32 v32, v128, v32, s[16:17]
    v_cndmask_b32 v33, v129, v33, s[18:19]
    v_cndmask_b32 v34, v130, v34, s[20:21]
    v_cndmask_b32 v35, v131, v35, s[22:23]
    v_cndmask_b32 v36, v132, v36, s[24:25]
    v_cndmask_b32 v37, v133, v37, s[26:27]
    v_cndmask_b32 v38, v134, v38, s[28:29]
    v_cndmask_b32 v39, v135, v39, s[30:31]
    v_cndmask_b32 v40, v136, v40, s[32:33]
    v_cndmask_b32 v41, v137, v41, s[34:35]
    v_cndmask_b32 v42, v138, v42, s[36:37]
    v_cndmask_b32 v43, v139, v43, s[38:39]
    v_cndmask_b32 v44, v140, v44, s[40:41]
    v_cndmask_b32 v45, v141, v45, s[42:43]
    v_cndmask_b32 v46, v142, v46, s[44:45]
    v_cndmask_b32 v47, v143, v47, s[46:47]
    v_exp_f32 v32, v32
    v_exp_f32 v33, v33
    v_exp_f32 v34, v34
    v_exp_f32 v35, v35
    v_exp_f32 v36, v36
    v_exp_f32 v37, v37
    v_exp_f32 v38, v38
    v_exp_f32 v39, v39
    v_exp_f32 v40, v40
    v_exp_f32 v41, v41
    v_exp_f32 v42, v42
    v_exp_f32 v43, v43
    v_exp_f32 v44, v44
    v_exp_f32 v45, v45
    v_exp_f32 v46, v46
    v_exp_f32 v47, v47
    v_cvt_pk_bf16_f32 v64, v32, v33
    v_cvt_pk_bf16_f32 v65, v34, v35
    v_cvt_pk_bf16_f32 v66, v36, v37
    v_cvt_pk_bf16_f32 v67, v38, v39
    v_cvt_pk_bf16_f32 v68, v40, v41
    v_cvt_pk_bf16_f32 v69, v42, v43
    v_cvt_pk_bf16_f32 v70, v44, v45
    v_cvt_pk_bf16_f32 v71, v46, v47
    v_bfi_b32 v128, v160, 0, v64
    v_and_b32 v64, v160, v64
    v_bfi_b32 v129, v161, 0, v65
    v_and_b32 v65, v161, v65
    v_bfi_b32 v130, v162, 0, v66
    v_and_b32 v66, v162, v66
    v_bfi_b32 v131, v163, 0, v67
    v_and_b32 v67, v163, v67
    v_bfi_b32 v132, v164, 0, v68
    v_and_b32 v68, v164, v68
    v_bfi_b32 v133, v165, 0, v69
    v_and_b32 v69, v165, v69
    v_bfi_b32 v134, v166, 0, v70
    v_and_b32 v70, v166, v70
    v_bfi_b32 v135, v167, 0, v71
    v_and_b32 v71, v167, v71
    v_exp_f32 v48, v48
    s_waitcnt lgkmcnt(2)
    s_cmp_eq_u32 s88, 7
    s_cbranch_scc1 L_rare_95
L_back_96:
    v_mfma_f32_32x32x16_bf16 v[32:47], v[144:147], v[156:159], v[96:111]
    ds_read_b128 v[144:147], v8 offset:3072
    v_exp_f32 v49, v49
    v_exp_f32 v50, v50
    v_exp_f32 v51, v51
    s_waitcnt lgkmcnt(4)
    v_mfma_f32_32x32x16_bf16 v[112:127], v[76:79], v[64:67], 0
    v_exp_f32 v52, v52
    v_exp_f32 v53, v53
    v_exp_f32 v54, v54
    v_exp_f32 v55, v55
    v_mfma_f32_32x32x16_bf16 v[112:127], v[80:83], v[68:71], v[112:127]
    s_mov_b64 exec, s[96:97]
    ds_read_b128 v[76:79], v9 offset:14336
    ds_read_b128 v[80:83], v9 offset:15360
    s_mov_b64 exec, -1
    v_exp_f32 v56, v56
    v_exp_f32 v57, v57
    v_exp_f32 v58, v58
    v_exp_f32 v59, v59
    v_mfma_f32_32x32x16_bf16 v[112:127], v[84:87], v[128:131], v[112:127]
    v_exp_f32 v60, v60
    v_exp_f32 v61, v61
    v_exp_f32 v62, v62
    v_exp_f32 v63, v63
    v_mfma_f32_32x32x16_bf16 v[112:127], v[88:91], v[132:135], v[112:127]
    s_mov_b64 exec, s[96:97]
    ds_read_b128 v[84:87], v9 offset:12288
    ds_read_b128 v[88:91], v9 offset:13312
    s_mov_b64 exec, -1
    v_cvt_pk_bf16_f32 v64, v48, v49
    v_cvt_pk_bf16_f32 v65, v50, v51
    v_cvt_pk_bf16_f32 v66, v52, v53
    v_cvt_pk_bf16_f32 v67, v54, v55
    v_cvt_pk_bf16_f32 v68, v56, v57
    v_cvt_pk_bf16_f32 v69, v58, v59
    v_cvt_pk_bf16_f32 v70, v60, v61
    v_cvt_pk_bf16_f32 v71, v62, v63
    v_exp_f32 v32, v32
    v_exp_f32 v33, v33
    s_waitcnt lgkmcnt(6)
    s_cmp_eq_u32 s88, 6
    s_cbranch_scc1 L_rare_97
L_back_98:
    v_mfma_f32_32x32x16_bf16 v[48:63], v[148:151], v[156:159], v[96:111]
    ds_read_b128 v[148:151], v8 offset:2048
    v_exp_f32 v34, v34
    v_exp_f32 v35, v35
    v_exp_f32 v36, v36
    v_exp_f32 v37, v37
    v_exp_f32 v38, v38
    s_waitcnt lgkmcnt(3)
    v_mfma_f32_32x32x16_bf16 v[112:127], v[76:79], v[64:67], v[112:127]
    v_exp_f32 v39, v39
    v_exp_f32 v40, v40
    v_exp_f32 v41, v41
    v_exp_f32 v42, v42
    v_exp_f32 v43, v43
    v_mfma_f32_32x32x16_bf16 v[112:127], v[80:83], v[68:71], v[112:127]
    s_mov_b64 exec, s[96:97]
    ds_read_b128 v[76:79], v9 offset:10240
    ds_read_b128 v[80:83], v9 offset:11264
    s_mov_b64 exec, -1
    v_exp_f32 v44, v44
    v_exp_f32 v45, v45
    v_exp_f32 v46, v46
    v_exp_f32 v47, v47
    v_cvt_pk_bf16_f32 v64, v32, v33
    v_cvt_pk_bf16_f32 v65, v34, v35
    v_cvt_pk_bf16_f32 v66, v36, v37
    v_cvt_pk_bf16_f32 v67, v38, v39
    v_cvt_pk_bf16_f32 v68, v40, v41
    v_cvt_pk_bf16_f32 v69, v42, v43
    v_cvt_pk_bf16_f32 v70, v44, v45
    v_cvt_pk_bf16_f32 v71, v46, v47
    v_exp_f32 v48, v48
    v_exp_f32 v49, v49
    s_waitcnt lgkmcnt(8)
    s_cmp_eq_u32 s88, 5
    s_cbranch_scc1 L_rare_99
L_back_100:
    v_mfma_f32_32x32x16_bf16 v[32:47], v[152:155], v[156:159], v[96:111]
    ds_read_b128 v[152:155], v8 offset:1024
    v_exp_f32 v50, v50
    v_exp_f32 v51, v51
    v_exp_f32 v52, v52
    v_exp_f32 v53, v53
    v_exp_f32 v54, v54
    s_waitcnt lgkmcnt(4)
    v_mfma_f32_32x32x16_bf16 v[112:127], v[84:87], v[64:67], v[112:127]
    v_exp_f32 v55, v55
    v_exp_f32 v56, v56
    v_exp_f32 v57, v57
    v_exp_f32 v58, v58
    v_exp_f32 v59, v59
    v_mfma_f32_32x32x16_bf16 v[112:127], v[88:91], v[68:71], v[112:127]
    s_mov_b64 exec, s[96:97]
    ds_read_b128 v[84:87], v9 offset:8192
    ds_read_b128 v[88:91], v9 offset:9216
    s_mov_b64 exec, -1
    v_exp_f32 v60, v60
    v_exp_f32 v61, v61
    v_exp_f32 v62, v62
    v_exp_f32 v63, v63
    v_cvt_pk_bf16_f32 v64, v48, v49
    v_cvt_pk_bf16_f32 v65, v50, v51
    v_cvt_pk_bf16_f32 v66, v52, v53
    v_cvt_pk_bf16_f32 v67, v54, v55
    v_cvt_pk_bf16_f32 v68, v56, v57
    v_cvt_pk_bf16_f32 v69, v58, v59
    v_cvt_pk_bf16_f32 v70, v60, v61
    v_cvt_pk_bf16_f32 v71, v62, v63
    v_exp_f32 v32, v32
    v_exp_f32 v33, v33
    s_waitcnt lgkmcnt(10)
    s_cmp_eq_u32 s88, 4
    s_cbranch_scc1 L_rare_101
L_back_102:
    v_mfma_f32_32x32x16_bf16 v[48:63], v[144:147], v[156:159], v[96:111]
    v_exp_f32 v34, v34
    v_exp_f32 v35, v35
    v_exp_f32 v36, v36
    v_exp_f32 v37, v37
    v_exp_f32 v38, v38
    s_waitcnt lgkmcnt(3)
    v_mfma_f32_32x32x16_bf16 v[112:127], v[76:79], v[64:67], v[112:127]
    v_exp_f32 v39, v39
    v_exp_f32 v40, v40
    v_exp_f32 v41, v41
    v_exp_f32 v42, v42
    v_exp_f32 v43, v43
    v_mfma_f32_32x32x16_bf16 v[112:127], v[80:83], v[68:71], v[112:127]
    s_mov_b64 exec, s[96:97]
    ds_read_b128 v[76:79], v9 offset:6144
    ds_read_b128 v[80:83], v9 offset:7168
    s_mov_b64 exec, -1
    v_exp_f32 v44, v44
    v_exp_f32 v45, v45
    v_exp_f32 v46, v46
    v_exp_f32 v47, v47
    v_cvt_pk_bf16_f32 v64, v32, v33
    v_cvt_pk_bf16_f32 v65, v34, v35
    v_cvt_pk_bf16_f32 v66, v36, v37
    v_cvt_pk_bf16_f32 v67, v38, v39
    v_cvt_pk_bf16_f32 v68, v40, v41
    v_cvt_pk_bf16_f32 v69, v42, v43
    v_cvt_pk_bf16_f32 v70, v44, v45
    v_cvt_pk_bf16_f32 v71, v46, v47
    v_exp_f32 v48, v48
    v_exp_f32 v49, v49
    s_waitcnt lgkmcnt(7)
    s_cmp_eq_u32 s88, 3
    s_cbranch_scc1 L_rare_103
L_back_104:
    v_mfma_f32_32x32x16_bf16 v[32:47], v[148:151], v[156:159], v[96:111]
    v_exp_f32 v50, v50
    v_exp_f32 v51, v51
    v_exp_f32 v52, v52
    v_exp_f32 v53, v53
    v_exp_f32 v54, v54
    s_waitcnt lgkmcnt(2)
    v_mfma_f32_32x32x16_bf16 v[112:127], v[84:87], v[64:67], v[112:127]
    v_exp_f32 v55, v55
    v_exp_f32 v56, v56
    v_exp_f32 v57, v57
    v_exp_f32 v58, v58
    v_exp_f32 v59, v59
    v_mfma_f32_32x32x16_bf16 v[112:127], v[88:91], v[68:71], v[112:127]
    s_mov_b64 exec, s[96:97]
    ds_read_b128 v[84:87], v9 offset:4096
    ds_read_b128 v[88:91], v9 offset:5120
    s_mov_b64 exec, -1
    v_exp_f32 v60, v60
    v_exp_f32 v61, v61
    v_exp_f32 v62, v62
    v_exp_f32 v63, v63
    v_cvt_pk_bf16_f32 v64, v48, v49
    v_cvt_pk_bf16_f32 v65, v50, v51
    v_cvt_pk_bf16_f32 v66, v52, v53
    v_cvt_pk_bf16_f32 v67, v54, v55
    v_cvt_pk_bf16_f32 v68, v56, v57
    v_cvt_pk_bf16_f32 v69, v58, v59
    v_cvt_pk_bf16_f32 v70, v60, v61
    v_cvt_pk_bf16_f32 v71, v62, v63
    v_exp_f32 v32, v32
    v_exp_f32 v33, v33
    s_waitcnt lgkmcnt(6)
    s_cmp_eq_u32 s88, 2
    s_cbranch_scc1 L_rare_105
L_back_106:
    v_mfma_f32_32x32x16_bf16 v[48:63], v[152:155], v[156:159], v[96:111]
    v_exp_f32 v34, v34
    v_exp_f32 v35, v35
    v_exp_f32 v36, v36
    v_exp_f32 v37, v37
    v_exp_f32 v38, v38
    s_waitcnt lgkmcnt(2)
    v_mfma_f32_32x32x16_bf16 v[112:127], v[76:79], v[64:67], v[112:127]
    v_exp_f32 v39, v39
    v_exp_f32 v40, v40
    v_exp_f32 v41, v41
    v_exp_f32 v42, v42
    v_exp_f32 v43, v43
    v_mfma_f32_32x32x16_bf16 v[112:127], v[80:83], v[68:71], v[112:127]
    s_mov_b64 exec, s[96:97]
    ds_read_b128 v[76:79], v9 offset:2048
    ds_read_b128 v[80:83], v9 offset:3072
    s_mov_b64 exec, -1
    v_exp_f32 v44, v44
    v_exp_f32 v45, v45
    v_exp_f32 v46, v46
    v_exp_f32 v47, v47
    v_cvt_pk_bf16_f32 v64, v32, v33
    v_cvt_pk_bf16_f32 v65, v34, v35
    v_cvt_pk_bf16_f32 v66, v36, v37
    v_cvt_pk_bf16_f32 v67, v38, v39
    v_cvt_pk_bf16_f32 v68, v40, v41
    v_cvt_pk_bf16_f32 v69, v42, v43
    v_cvt_pk_bf16_f32 v70, v44, v45
    v_cvt_pk_bf16_f32 v71, v46, v47
    v_exp_f32 v48, v48
    v_exp_f32 v49, v49
    v_exp_f32 v50, v50
    v_exp_f32 v51, v51
    v_exp_f32 v52, v52
    v_exp_f32 v53, v53
    v_exp_f32 v54, v54
    s_waitcnt lgkmcnt(2)
    v_mfma_f32_32x32x16_bf16 v[112:127], v[84:87], v[64:67], v[112:127]
    v_exp_f32 v55, v55
    v_exp_f32 v56, v56
    v_exp_f32 v57, v57
    v_exp_f32 v58, v58
    v_exp_f32 v59, v59
    v_mfma_f32_32x32x16_bf16 v[112:127], v[88:91], v[68:71], v[112:127]
    v_exp_f32 v60, v60
    v_exp_f32 v61, v61
    v_exp_f32 v62, v62
    v_exp_f32 v63, v63
    v_cvt_pk_bf16_f32 v64, v48, v49
    v_cvt_pk_bf16_f32 v65, v50, v51
    v_cvt_pk_bf16_f32 v66, v52, v53
    v_cvt_pk_bf16_f32 v67, v54, v55
    v_cvt_pk_bf16_f32 v68, v56, v57
    v_cvt_pk_bf16_f32 v69, v58, v59
    v_cvt_pk_bf16_f32 v70, v60, v61
    v_cvt_pk_bf16_f32 v71, v62, v63
    s_waitcnt lgkmcnt(0)
    v_mfma_f32_32x32x16_bf16 v[112:127], v[76:79], v[64:67], v[112:127]
    v_mfma_f32_32x32x16_bf16 v[112:127], v[80:83], v[68:71], v[112:127]
    s_nop 12
    s_nop 1
    s_branch L_back_46
L_rare_75:
    s_nop 7
    v_mov_b32 v28, 0xff800000
    v_mov_b32 v29, 0xff800000
    v_mov_b64 v[96:97], v[28:29]
    v_mov_b64 v[98:99], v[28:29]
    v_mov_b64 v[100:101], v[28:29]
    v_mov_b64 v[102:103], v[28:29]
    v_mov_b64 v[104:105], v[28:29]
    v_mov_b64 v[106:107], v[28:29]
    v_mov_b64 v[108:109], v[28:29]
    v_mov_b64 v[110:111], v[28:29]
    s_nop 1
    s_branch L_back_76
L_rare_77:
    s_nop 12
    v_mov_b32 v28, 0xff800000
    v_mov_b32 v29, 0xff800000
    v_mov_b64 v[128:129], v[28:29]
    v_mov_b64 v[130:131], v[28:29]
    v_mov_b64 v[132:133], v[28:29]
    v_mov_b64 v[134:135], v[28:29]
    v_mov_b64 v[136:137], v[28:29]
    v_mov_b64 v[138:139], v[28:29]
    v_mov_b64 v[140:141], v[28:29]
    v_mov_b64 v[142:143], v[28:29]
    s_nop 0
    s_branch L_back_78
L_rare_79:
    s_nop 7
    v_mov_b32 v28, 0xff800000
    v_mov_b32 v29, 0xff800000
    v_mov_b64 v[96:97], v[28:29]
    v_mov_b64 v[98:99], v[28:29]
    v_mov_b64 v[100:101], v[28:29]
    v_mov_b64 v[102:103], v[28:29]
    v_mov_b64 v[104:105], v[28:29]
    v_mov_b64 v[106:107], v[28:29]
    v_mov_b64 v[108:109], v[28:29]
    v_mov_b64 v[110:111], v[28:29]
    s_nop 1
    s_branch L_back_80
L_rare_81:
    s_nop 7
    v_mov_b32 v28, 0xff800000
    v_mov_b32 v29, 0xff800000
    v_mov_b64 v[96:97], v[28:29]
    v_mov_b64 v[98:99], v[28:29]
    v_mov_b64 v[100:101], v[28:29]
    v_mov_b64 v[102:103], v[28:29]
    v_mov_b64 v[104:105], v[28:29]
    v_mov_b64 v[106:107], v[28:29]
    v_mov_b64 v[108:109], v[28:29]
    v_mov_b64 v[110:111], v[28:29]
    s_nop 1
    s_branch L_back_82
L_rare_83:
    s_nop 7
    v_mov_b32 v28, 0xff800000
    v_mov_b32 v29, 0xff800000
    v_mov_b64 v[96:97], v[28:29]
    v_mov_b64 v[98:99], v[28:29]
    v_mov_b64 v[100:101], v[28:29]
    v_mov_b64 v[102:103], v[28:29]
    v_mov_b64 v[104:105], v[28:29]
    v_mov_b64 v[106:107], v[28:29]
    v_mov_b64 v[108:109], v[28:29]
    v_mov_b64 v[110:111], v[28:29]
    s_nop 1
    s_branch L_back_84
L_rare_85:
    s_nop 7
    v_mov_b32 v28, 0xff800000
    v_mov_b32 v29, 0xff800000
    v_mov_b64 v[96:97], v[28:29]
    v_mov_b64 v[98:99], v[28:29]
    v_mov_b64 v[100:101], v[28:29]
    v_mov_b64 v[102:103], v[28:29]
    v_mov_b64 v[104:105], v[28:29]
    v_mov_b64 v[106:107], v[28:29]
    v_mov_b64 v[108:109], v[28:29]
    v_mov_b64 v[110:111], v[28:29]
    s_nop 1
    s_branch L_back_86
L_rare_87:
    s_nop 7
    v_mov_b32 v28, 0xff800000
    v_mov_b32 v29, 0xff800000
    v_mov_b64 v[96:97], v[28:29]
    v_mov_b64 v[98:99], v[28:29]
    v_mov_b64 v[100:101], v[28:29]
    v_mov_b64 v[102:103], v[28:29]
    v_mov_b64 v[104:105], v[28:29]
    v_mov_b64 v[106:107], v[28:29]
    v_mov_b64 v[108:109], v[28:29]
    v_mov_b64 v[110:111], v[28:29]
    s_nop 1
    s_branch L_back_88
L_rare_89:
    s_nop 7
    v_mov_b32 v28, 0xff800000
    v_mov_b32 v29, 0xff800000
    v_mov_b64 v[96:97], v[28:29]
    v_mov_b64 v[98:99], v[28:29]
    v_mov_b64 v[100:101], v[28:29]
    v_mov_b64 v[102:103], v[28:29]
    v_mov_b64 v[104:105], v[28:29]
    v_mov_b64 v[106:107], v[28:29]
    v_mov_b64 v[108:109], v[28:29]
    v_mov_b64 v[110:111], v[28:29]
    s_nop 1
    s_branch L_back_90
L_rare_91:
    s_nop 7
    v_mov_b32 v28, 0xff800000
    v_mov_b32 v29, 0xff800000
    v_mov_b64 v[96:97], v[28:29]
    v_mov_b64 v[98:99], v[28:29]
    v_mov_b64 v[100:101], v[28:29]
    v_mov_b64 v[102:103], v[28:29]
    v_mov_b64 v[104:105], v[28:29]
    v_mov_b64 v[106:107], v[28:29]
    v_mov_b64 v[108:109], v[28:29]
    v_mov_b64 v[110:111], v[28:29]
    s_nop 1
    s_branch L_back_92
L_rare_93:
    s_nop 12
    v_mov_b32 v28, 0xff800000
    v_mov_b32 v29, 0xff800000
    v_mov_b64 v[128:129], v[28:29]
    v_mov_b64 v[130:131], v[28:29]
    v_mov_b64 v[132:133], v[28:29]
    v_mov_b64 v[134:135], v[28:29]
    v_mov_b64 v[136:137], v[28:29]
    v_mov_b64 v[138:139], v[28:29]
    v_mov_b64 v[140:141], v[28:29]
    v_mov_b64 v[142:143], v[28:29]
    s_nop 0
    s_branch L_back_94
L_rare_95:
    s_nop 7
    v_mov_b32 v28, 0xff800000
    v_mov_b32 v29, 0xff800000
    v_mov_b64 v[96:97], v[28:29]
    v_mov_b64 v[98:99], v[28:29]
    v_mov_b64 v[100:101], v[28:29]
    v_mov_b64 v[102:103], v[28:29]
    v_mov_b64 v[104:105], v[28:29]
    v_mov_b64 v[106:107], v[28:29]
    v_mov_b64 v[108:109], v[28:29]
    v_mov_b64 v[110:111], v[28:29]
    s_nop 1
    s_branch L_back_96
L_rare_97:
    s_nop 7
    v_mov_b32 v28, 0xff800000
    v_mov_b32 v29, 0xff800000
    v_mov_b64 v[96:97], v[28:29]
    v_mov_b64 v[98:99], v[28:29]
    v_mov_b64 v[100:101], v[28:29]
    v_mov_b64 v[102:103], v[28:29]
    v_mov_b64 v[104:105], v[28:29]
    v_mov_b64 v[106:107], v[28:29]
    v_mov_b64 v[108:109], v[28:29]
    v_mov_b64 v[110:111], v[28:29]
    s_nop 1
    s_branch L_back_98
L_rare_99:
    s_nop 7
    v_mov_b32 v28, 0xff800000
    v_mov_b32 v29, 0xff800000
    v_mov_b64 v[96:97], v[28:29]
    v_mov_b64 v[98:99], v[28:29]
    v_mov_b64 v[100:101], v[28:29]
    v_mov_b64 v[102:103], v[28:29]
    v_mov_b64 v[104:105], v[28:29]
    v_mov_b64 v[106:107], v[28:29]
    v_mov_b64 v[108:109], v[28:29]
    v_mov_b64 v[110:111], v[28:29]
    s_nop 1
    s_branch L_back_100
L_rare_101:
    s_nop 7
    v_mov_b32 v28, 0xff800000
    v_mov_b32 v29, 0xff800000
    v_mov_b64 v[96:97], v[28:29]
    v_mov_b64 v[98:99], v[28:29]
    v_mov_b64 v[100:101], v[28:29]
    v_mov_b64 v[102:103], v[28:29]
    v_mov_b64 v[104:105], v[28:29]
    v_mov_b64 v[106:107], v[28:29]
    v_mov_b64 v[108:109], v[28:29]
    v_mov_b64 v[110:111], v[28:29]
    s_nop 1
    s_branch L_back_102
L_rare_103:
    s_nop 7
    v_mov_b32 v28, 0xff800000
    v_mov_b32 v29, 0xff800000
    v_mov_b64 v[96:97], v[28:29]
    v_mov_b64 v[98:99], v[28:29]
    v_mov_b64 v[100:101], v[28:29]
    v_mov_b64 v[102:103], v[28:29]
    v_mov_b64 v[104:105], v[28:29]
    v_mov_b64 v[106:107], v[28:29]
    v_mov_b64 v[108:109], v[28:29]
    v_mov_b64 v[110:111], v[28:29]
    s_nop 1
    s_branch L_back_104
L_rare_105:
    s_nop 7
    v_mov_b32 v28, 0xff800000
    v_mov_b32 v29, 0xff800000
    v_mov_b64 v[96:97], v[28:29]
    v_mov_b64 v[98:99], v[28:29]
    v_mov_b64 v[100:101], v[28:29]
    v_mov_b64 v[102:103], v[28:29]
    v_mov_b64 v[104:105], v[28:29]
    v_mov_b64 v[106:107], v[28:29]
    v_mov_b64 v[108:109], v[28:29]
    v_mov_b64 v[110:111], v[28:29]
    s_nop 1
    s_branch L_back_106
.set CODE_LAST, L_hot_end - gated_mix__sliding_block__mixer_channel_mlp__prompt_kernel - 64
.section .rodata,"a"
.p2align 6
.amdhsa_kernel gated_mix__sliding_block__mixer_channel_mlp__prompt_kernel
  .amdhsa_next_free_vgpr 256
  .amdhsa_next_free_sgpr 102
  .amdhsa_accum_offset 256
  .amdhsa_group_segment_fixed_size 0
  .amdhsa_kernarg_size 96
  .amdhsa_user_sgpr_count 2
  .amdhsa_user_sgpr_kernarg_segment_ptr 1
  .amdhsa_system_sgpr_workgroup_id_x 1
.end_amdhsa_kernel
.p2align 7
.type L_tab,@object
L_tab:
.set tb_N, 0
.rept 2048
.set tb_G, (tb_N>>3)
.set tb_W, (tb_N&7)
.set tb_T, (tb_W&3)
.set tb_S, (tb_W>>2)
.set tb_R, (((tb_G&6)*2)+(tb_G>>6))
.set tb_C, (((tb_G&1)*8)+((tb_G>>3)&7))
.set tb_X, (tb_T^(tb_S*2))
.set tb_TT, ((tb_R*4)+tb_T)
.set tb_CS, ((tb_C*2)+tb_S)
.set tb_T3, (((tb_C>>3)*2)+(tb_W&1))
.set tb_RO, (((tb_C&7)+((tb_R&3)*2))&7)
.set tb_CB, ((tb_C&7)^(1+((tb_C>>3)*3)))
.set tb_I0, (((1-tb_S)*(((tb_R*4)-8)+((tb_W&1)*6)))+(tb_S*(((tb_R*8)-16)+(tb_T*6))))
.long ((((tb_W>>1)*44032)+(tb_C*192))+(((tb_C+1)>>4)<<30))
.long (((((tb_W>>1)*16)*(2752+((tb_W&1)*320)))+(tb_C*(192-((tb_W&1)*128))))+((((tb_C+1)>>4)*(1-(tb_W&1)))<<30))
.long ((tb_CB*128)+(tb_W*8192))
.long (((tb_X*4096)+64)+(tb_S*64))
.long (((tb_X*4096)+3072)+(tb_S*32))
.long (((tb_X*4096)+32)-(tb_S*32))
.long (((tb_C*6)-tb_S)*32)
.long ((((tb_C*3)+tb_S)+1)*64)
.long ((tb_CB*128)+((((tb_W>>1)+3)>>2)<<30))
.long ((98304+(tb_S*12288))+(tb_T*1024))
.long ((122880+(tb_T*2048))+(tb_S*256))
.long (131072+(((tb_R*4)+tb_T3)*1024))
.long (((tb_W>>1)*2048)+98304)
.long ((tb_C*2048)+65536)
.long ((tb_W&1)*128)
.long (1376+((tb_W&1)*160))
.long ((262144+(tb_CS*131072))+(tb_TT*(1024+((tb_C>>3)*1024))))
.long (((262144+(tb_CS*131072))+(tb_TT*(1024+((tb_C>>3)*1024))))+(65536-((tb_C>>3)*64512)))
.long ((65536+(((tb_CS*16)+tb_R)*128))+(tb_T*8))
.long ((131072+(((tb_TT*8)+(tb_C>>1))*128))+((tb_CS&3)*8))
.long (((4456448+(tb_TT*131072))+((((tb_C*6)+2)+(tb_S*2))*1024))+(((tb_CS+3)>>5)<<30))
.long (((4456448+(tb_TT*131072))+((((tb_C*6)+1)-tb_S)*1024))+(((tb_CS+2)>>5)<<30))
.long ((4456448+(tb_TT*131072))+((96+tb_CS)*1024))
.long ((4456448+(((tb_R*4)+tb_T3)*131072))+((tb_W>>1)*1024))
.long ((8-tb_TT)*(1-((tb_TT+56)>>6)))
.long (((((tb_R*128)+((tb_C>>3)*64))+(tb_W*8))*1024)+(tb_CB*128))
.long ((((tb_C*131072)+(((1-tb_S)*(262144+((tb_W>>1)*65536)))+(tb_S*2359296))))+(tb_I0*1024))
.long tb_I0
.long (((tb_RO*11)>>2)<<16)
.long (((tb_RO*11)>>2)<<12)
.long tb_RO
.long (160768+(tb_T3*128))
.set tb_N, tb_N+1
.endr
.size L_tab, 262144
```
